```python
import torch

def _softmax(x, axis=-1):
    return torch.softmax(x, dim=axis)
def _gelu(x):
    return torch.nn.functional.gelu(x, approximate="tanh")
def _silu(x):
    return torch.nn.functional.silu(x)
def _sigmoid(x):
    return torch.sigmoid(x)
def _layernorm(x, axis=-1, eps=1e-5):
    m = x.mean(dim=axis, keepdim=True)
    v = x.var(dim=axis, keepdim=True, unbiased=False)
    return (x - m) / torch.sqrt(v + eps)
def _scatter_add(tgt, idx, src, axis=0):
    return tgt.clone().index_add_(axis, idx, src)
def _segment_sum(src, seg, n):
    out = torch.zeros((n,) + src.shape[1:], dtype=src.dtype)
    return out.index_add_(0, seg, src)
def _pad(x, pw):
    flat = tuple(v for pair in reversed(pw) for v in pair)
    return torch.nn.functional.pad(x, flat)

kernel_name = 'standalone__dense_activation_silu__prompt'

def setup_inputs():

    _w = (lambda a: (lambda t: t.to(torch.bfloat16) if t.is_floating_point() else t)(torch.as_tensor(a)))
    B, S, D, F = 1, 2048, 640, 1728
    return {
        "x": _w((lambda *s: torch.randn(*s, dtype=torch.bfloat16) * 0.1)(B, S, D)),
        "w1": _w((lambda *s: torch.randn(*s, dtype=torch.bfloat16) * 3.2)(D, F) * (D ** -0.5)),
        "w2": _w((lambda *s: torch.randn(*s, dtype=torch.bfloat16) * 3.2)(F, D) * (F ** -0.5)),
    }

def reference(x, w1, w2):
    h = torch.einsum("bsd,df->bsf", x, w1)
    h = _silu(h)
    out = torch.einsum("bsf,fd->bsd", h, w2)
    return out
```

```asm
; @launch kernel=ffn1_kernel grid=(256,1,1) block=(256,1,1) lds=131072
; @launch kernel=ffn2_kernel grid=(256,1,1) block=(256,1,1) lds=64512
.amdgcn_target "amdgcn-amd-amdhsa--gfx950"
.text
.globl ffn1_kernel
.p2align 8
.type ffn1_kernel,@function
ffn1_kernel:
    s_cmp_ge_u32 s2, 224
    s_cbranch_scc1 L1_helper
    s_load_dwordx4 s[4:7], s[0:1], 0
    s_load_dwordx2 s[8:9], s[0:1], 40
    v_and_b32 v1, 63, v0
    v_lshrrev_b32 v2, 6, v0
    s_nop 0
    v_readfirstlane_b32 s24, v2
    s_and_b32 s31, s2, 7
    s_lshr_b32 s33, s2, 3
    s_and_b32 s34, s33, 3
    s_lshr_b32 s35, s33, 2
    s_lshr_b32 s25, s31, 1
    s_lshl_b32 s25, s25, 9
    s_lshl_b32 s34, s34, 7
    s_add_u32 s25, s25, s34
    s_and_b32 s31, s31, 1
    s_mul_i32 s42, s31, 864
    s_lshl_b32 s26, s35, 7
    s_add_u32 s26, s26, s42
    s_add_u32 s42, s42, 864
    s_and_b32 s37, s24, 1
    s_lshr_b32 s38, s24, 1
    s_lshl_b32 s27, s24, 12
    s_add_u32 s28, s27, 0x10000
    s_lshl_b32 s36, s24, 5
    s_add_u32 s36, s36, s25
    v_lshrrev_b32 v2, 3, v1
    v_and_b32 v3, 7, v1
    v_lshrrev_b32 v4, 4, v1
    v_add_u32 v5, 0, v4
    v_xor_b32 v5, v3, v5
    v_lshlrev_b32 v5, 4, v5
    v_add_u32 v6, 0, v2
    v_add_u32 v6, s36, v6
    v_mul_u32_u24 v6, 1280, v6
    v_add_u32 v10, v6, v5
    v_add_u32 v5, 4, v4
    v_xor_b32 v5, v3, v5
    v_lshlrev_b32 v5, 4, v5
    v_add_u32 v6, 8, v2
    v_add_u32 v6, s36, v6
    v_mul_u32_u24 v6, 1280, v6
    v_add_u32 v11, v6, v5
    v_add_u32 v5, 0, v4
    v_xor_b32 v5, v3, v5
    v_lshlrev_b32 v5, 4, v5
    v_add_u32 v6, 16, v2
    v_add_u32 v6, s36, v6
    v_mul_u32_u24 v6, 1280, v6
    v_add_u32 v12, v6, v5
    v_add_u32 v5, 4, v4
    v_xor_b32 v5, v3, v5
    v_lshlrev_b32 v5, 4, v5
    v_add_u32 v6, 24, v2
    v_add_u32 v6, s36, v6
    v_mul_u32_u24 v6, 1280, v6
    v_add_u32 v13, v6, v5
    v_and_b32 v5, 15, v1
    v_lshlrev_b32 v6, 2, v4
    v_xor_b32 v5, v5, v6
    v_lshlrev_b32 v5, 4, v5
    s_lshl_b32 s39, s26, 1
    v_add_u32 v5, s39, v5
    s_lshl_b32 s39, s24, 4
    v_add_u32 v6, 0, v4
    v_add_u32 v6, s39, v6
    v_mul_u32_u24 v6, 3456, v6
    v_add_u32 v14, v6, v5
    v_add_u32 v6, 4, v4
    v_add_u32 v6, s39, v6
    v_mul_u32_u24 v6, 3456, v6
    v_add_u32 v15, v6, v5
    v_add_u32 v6, 8, v4
    v_add_u32 v6, s39, v6
    v_mul_u32_u24 v6, 3456, v6
    v_add_u32 v16, v6, v5
    v_add_u32 v6, 12, v4
    v_add_u32 v6, s39, v6
    v_mul_u32_u24 v6, 3456, v6
    v_add_u32 v17, v6, v5
    s_waitcnt lgkmcnt(0)
    s_mov_b32 s12, s4
    s_and_b32 s13, s5, 0xffff
    s_mov_b32 s14, 2621440
    s_mov_b32 s15, 0x20000
    s_mov_b32 s16, s6
    s_and_b32 s17, s7, 0xffff
    s_mov_b32 s18, 2211840
    s_mov_b32 s19, 0x20000
    s_mov_b32 s20, s8
    s_and_b32 s21, s9, 0xffff
    s_mov_b32 s22, 7077888
    s_mov_b32 s23, 0x20000
    s_mov_b32 s29, 0
    s_mov_b32 s30, 0
    s_add_u32 m0, s27, 0
    s_nop 0
    buffer_load_dwordx4 v10, s[12:15], s29 offen lds
    s_add_u32 m0, s27, 1024
    s_nop 0
    buffer_load_dwordx4 v11, s[12:15], s29 offen lds
    s_add_u32 m0, s27, 2048
    s_nop 0
    buffer_load_dwordx4 v12, s[12:15], s29 offen lds
    s_add_u32 m0, s27, 3072
    s_nop 0
    buffer_load_dwordx4 v13, s[12:15], s29 offen lds
    s_add_u32 m0, s28, 0
    s_nop 0
    buffer_load_dwordx4 v14, s[16:19], s30 offen lds
    s_add_u32 m0, s28, 1024
    s_nop 0
    buffer_load_dwordx4 v15, s[16:19], s30 offen lds
    s_add_u32 m0, s28, 2048
    s_nop 0
    buffer_load_dwordx4 v16, s[16:19], s30 offen lds
    s_add_u32 m0, s28, 3072
    s_nop 0
    buffer_load_dwordx4 v17, s[16:19], s30 offen lds
    v_and_b32 v5, 31, v1
    v_lshrrev_b32 v6, 1, v5
    v_and_b32 v6, 7, v6
    v_lshrrev_b32 v7, 5, v1
    s_lshl_b32 s39, s37, 6
    v_add_u32 v5, s39, v5
    v_lshlrev_b32 v5, 7, v5
    v_add_u32 v8, 0, v7
    v_xor_b32 v8, v8, v6
    v_lshlrev_b32 v8, 4, v8
    v_add_u32 v18, v5, v8
    v_add_u32 v8, 2, v7
    v_xor_b32 v8, v8, v6
    v_lshlrev_b32 v8, 4, v8
    v_add_u32 v19, v5, v8
    v_add_u32 v8, 4, v7
    v_xor_b32 v8, v8, v6
    v_lshlrev_b32 v8, 4, v8
    v_add_u32 v20, v5, v8
    v_add_u32 v8, 6, v7
    v_xor_b32 v8, v8, v6
    v_lshlrev_b32 v8, 4, v8
    v_add_u32 v21, v5, v8
    v_and_b32 v5, 15, v1
    v_lshrrev_b32 v6, 2, v5
    v_and_b32 v5, 3, v5
    v_lshrrev_b32 v7, 1, v4
    v_lshlrev_b32 v7, 3, v7
    v_add_u32 v7, v7, v6
    v_lshlrev_b32 v7, 8, v7
    v_and_b32 v8, 1, v5
    v_lshlrev_b32 v8, 3, v8
    v_add_u32 v7, v7, v8
    v_add_u32 v7, 0x10000, v7
    v_and_b32 v8, 1, v4
    v_lshlrev_b32 v8, 1, v8
    v_lshrrev_b32 v9, 1, v5
    v_add_u32 v8, v8, v9
    s_lshl_b32 s39, s38, 3
    v_add_u32 v8, s39, v8
    v_lshlrev_b32 v9, 2, v6
    v_add_u32 v2, 0, v8
    v_xor_b32 v2, v2, v9
    v_lshlrev_b32 v2, 4, v2
    v_add_u32 v22, v7, v2
    v_add_u32 v2, 4, v8
    v_xor_b32 v2, v2, v9
    v_lshlrev_b32 v2, 4, v2
    v_add_u32 v23, v7, v2
    v_and_b32 v5, 1, v4
    v_lshlrev_b32 v5, 10, v5
    v_and_b32 v6, 15, v1
    v_lshlrev_b32 v6, 4, v6
    v_add_u32 v5, v5, v6
    v_lshrrev_b32 v6, 5, v1
    v_lshlrev_b32 v6, 8, v6
    v_add_u32 v24, v5, v6
    s_lshl_b32 s39, s37, 6
    s_add_u32 s39, s39, s25
    s_lshr_b32 s39, s39, 6
    s_mul_i32 s39, s39, 54
    s_lshl_b32 s40, s38, 6
    s_add_u32 s40, s40, s26
    s_lshr_b32 s41, s40, 5
    s_add_u32 s39, s39, s41
    s_lshl_b32 s32, s39, 12
    s_mov_b32 s29, 128
    s_mov_b32 s30, 221184
    s_add_u32 m0, s27, 16384
    s_nop 0
    buffer_load_dwordx4 v10, s[12:15], s29 offen lds
    s_add_u32 m0, s27, 17408
    s_nop 0
    buffer_load_dwordx4 v11, s[12:15], s29 offen lds
    s_add_u32 m0, s27, 18432
    s_nop 0
    buffer_load_dwordx4 v12, s[12:15], s29 offen lds
    s_add_u32 m0, s27, 19456
    s_nop 0
    buffer_load_dwordx4 v13, s[12:15], s29 offen lds
    s_add_u32 m0, s28, 16384
    s_nop 0
    buffer_load_dwordx4 v14, s[16:19], s30 offen lds
    s_add_u32 m0, s28, 17408
    s_nop 0
    buffer_load_dwordx4 v15, s[16:19], s30 offen lds
    s_add_u32 m0, s28, 18432
    s_nop 0
    buffer_load_dwordx4 v16, s[16:19], s30 offen lds
    s_add_u32 m0, s28, 19456
    s_nop 0
    buffer_load_dwordx4 v17, s[16:19], s30 offen lds
    s_mov_b32 s29, 256
    s_mov_b32 s30, 442368
    s_add_u32 m0, s27, 32768
    s_nop 0
    buffer_load_dwordx4 v10, s[12:15], s29 offen lds
    s_add_u32 m0, s27, 33792
    s_nop 0
    buffer_load_dwordx4 v11, s[12:15], s29 offen lds
    s_add_u32 m0, s27, 34816
    s_nop 0
    buffer_load_dwordx4 v12, s[12:15], s29 offen lds
    s_add_u32 m0, s27, 35840
    s_nop 0
    buffer_load_dwordx4 v13, s[12:15], s29 offen lds
    s_add_u32 m0, s28, 32768
    s_nop 0
    buffer_load_dwordx4 v14, s[16:19], s30 offen lds
    s_add_u32 m0, s28, 33792
    s_nop 0
    buffer_load_dwordx4 v15, s[16:19], s30 offen lds
    s_add_u32 m0, s28, 34816
    s_nop 0
    buffer_load_dwordx4 v16, s[16:19], s30 offen lds
    s_add_u32 m0, s28, 35840
    s_nop 0
    buffer_load_dwordx4 v17, s[16:19], s30 offen lds
    s_waitcnt vmcnt(16)
    s_barrier
    ds_read_b128 v[32:35], v18 offset:0
    ds_read_b64_tr_b16 v[40:41], v22 offset:0
    ds_read_b64_tr_b16 v[42:43], v22 offset:1024
    ds_read_b128 v[36:39], v18 offset:4096
    ds_read_b64_tr_b16 v[44:45], v23 offset:0
    ds_read_b64_tr_b16 v[46:47], v23 offset:1024
    s_waitcnt lgkmcnt(0)
    v_mfma_f32_32x32x16_bf16 v[64:79], v[40:43], v[32:35], 0
    ds_read_b128 v[48:51], v19 offset:0
    ds_read_b64_tr_b16 v[56:57], v22 offset:4096
    ds_read_b64_tr_b16 v[58:59], v22 offset:5120
    v_mfma_f32_32x32x16_bf16 v[80:95], v[40:43], v[36:39], 0
    ds_read_b128 v[52:55], v19 offset:4096
    ds_read_b64_tr_b16 v[60:61], v23 offset:4096
    ds_read_b64_tr_b16 v[62:63], v23 offset:5120
    s_mov_b32 s29, 384
    s_mov_b32 s30, 663552
    s_add_u32 m0, s27, 49152
    s_nop 0
    buffer_load_dwordx4 v10, s[12:15], s29 offen lds
    v_mfma_f32_32x32x16_bf16 v[96:111], v[44:47], v[32:35], 0
    s_add_u32 m0, s27, 50176
    s_nop 0
    buffer_load_dwordx4 v11, s[12:15], s29 offen lds
    s_add_u32 m0, s27, 51200
    s_nop 0
    buffer_load_dwordx4 v12, s[12:15], s29 offen lds
    v_mfma_f32_32x32x16_bf16 v[112:127], v[44:47], v[36:39], 0
    s_waitcnt lgkmcnt(0)
    v_mfma_f32_32x32x16_bf16 v[64:79], v[56:59], v[48:51], v[64:79]
    ds_read_b128 v[32:35], v20 offset:0
    ds_read_b64_tr_b16 v[40:41], v22 offset:8192
    ds_read_b64_tr_b16 v[42:43], v22 offset:9216
    v_mfma_f32_32x32x16_bf16 v[80:95], v[56:59], v[52:55], v[80:95]
    ds_read_b128 v[36:39], v20 offset:4096
    ds_read_b64_tr_b16 v[44:45], v23 offset:8192
    ds_read_b64_tr_b16 v[46:47], v23 offset:9216
    s_add_u32 m0, s27, 52224
    s_nop 0
    buffer_load_dwordx4 v13, s[12:15], s29 offen lds
    v_mfma_f32_32x32x16_bf16 v[96:111], v[60:63], v[48:51], v[96:111]
    s_add_u32 m0, s28, 49152
    s_nop 0
    buffer_load_dwordx4 v14, s[16:19], s30 offen lds
    s_add_u32 m0, s28, 50176
    s_nop 0
    buffer_load_dwordx4 v15, s[16:19], s30 offen lds
    v_mfma_f32_32x32x16_bf16 v[112:127], v[60:63], v[52:55], v[112:127]
    s_waitcnt lgkmcnt(0)
    v_mfma_f32_32x32x16_bf16 v[64:79], v[40:43], v[32:35], v[64:79]
    ds_read_b128 v[48:51], v21 offset:0
    ds_read_b64_tr_b16 v[56:57], v22 offset:12288
    ds_read_b64_tr_b16 v[58:59], v22 offset:13312
    v_mfma_f32_32x32x16_bf16 v[80:95], v[40:43], v[36:39], v[80:95]
    ds_read_b128 v[52:55], v21 offset:4096
    ds_read_b64_tr_b16 v[60:61], v23 offset:12288
    ds_read_b64_tr_b16 v[62:63], v23 offset:13312
    s_add_u32 m0, s28, 51200
    s_nop 0
    buffer_load_dwordx4 v16, s[16:19], s30 offen lds
    v_mfma_f32_32x32x16_bf16 v[96:111], v[44:47], v[32:35], v[96:111]
    s_add_u32 m0, s28, 52224
    s_nop 0
    buffer_load_dwordx4 v17, s[16:19], s30 offen lds
    v_mfma_f32_32x32x16_bf16 v[112:127], v[44:47], v[36:39], v[112:127]
    s_waitcnt lgkmcnt(0)
    v_mfma_f32_32x32x16_bf16 v[64:79], v[56:59], v[48:51], v[64:79]
    s_waitcnt vmcnt(16)
    s_barrier
    ds_read_b128 v[32:35], v18 offset:16384
    ds_read_b64_tr_b16 v[40:41], v22 offset:16384
    ds_read_b64_tr_b16 v[42:43], v22 offset:17408
    v_mfma_f32_32x32x16_bf16 v[80:95], v[56:59], v[52:55], v[80:95]
    ds_read_b128 v[36:39], v18 offset:20480
    ds_read_b64_tr_b16 v[44:45], v23 offset:16384
    ds_read_b64_tr_b16 v[46:47], v23 offset:17408
    s_mov_b32 s29, 512
    s_mov_b32 s30, 884736
    s_add_u32 m0, s27, 0
    s_nop 0
    buffer_load_dwordx4 v10, s[12:15], s29 offen lds
    v_mfma_f32_32x32x16_bf16 v[96:111], v[60:63], v[48:51], v[96:111]
    s_add_u32 m0, s27, 1024
    s_nop 0
    buffer_load_dwordx4 v11, s[12:15], s29 offen lds
    v_mfma_f32_32x32x16_bf16 v[112:127], v[60:63], v[52:55], v[112:127]
    s_waitcnt lgkmcnt(0)
    v_mfma_f32_32x32x16_bf16 v[64:79], v[40:43], v[32:35], v[64:79]
    ds_read_b128 v[48:51], v19 offset:16384
    ds_read_b64_tr_b16 v[56:57], v22 offset:20480
    ds_read_b64_tr_b16 v[58:59], v22 offset:21504
    v_mfma_f32_32x32x16_bf16 v[80:95], v[40:43], v[36:39], v[80:95]
    ds_read_b128 v[52:55], v19 offset:20480
    ds_read_b64_tr_b16 v[60:61], v23 offset:20480
    ds_read_b64_tr_b16 v[62:63], v23 offset:21504
    s_add_u32 m0, s27, 2048
    s_nop 0
    buffer_load_dwordx4 v12, s[12:15], s29 offen lds
    v_mfma_f32_32x32x16_bf16 v[96:111], v[44:47], v[32:35], v[96:111]
    s_add_u32 m0, s27, 3072
    s_nop 0
    buffer_load_dwordx4 v13, s[12:15], s29 offen lds
    s_add_u32 m0, s28, 0
    s_nop 0
    buffer_load_dwordx4 v14, s[16:19], s30 offen lds
    v_mfma_f32_32x32x16_bf16 v[112:127], v[44:47], v[36:39], v[112:127]
    s_waitcnt lgkmcnt(0)
    v_mfma_f32_32x32x16_bf16 v[64:79], v[56:59], v[48:51], v[64:79]
    ds_read_b128 v[32:35], v20 offset:16384
    ds_read_b64_tr_b16 v[40:41], v22 offset:24576
    ds_read_b64_tr_b16 v[42:43], v22 offset:25600
    v_mfma_f32_32x32x16_bf16 v[80:95], v[56:59], v[52:55], v[80:95]
    ds_read_b128 v[36:39], v20 offset:20480
    ds_read_b64_tr_b16 v[44:45], v23 offset:24576
    ds_read_b64_tr_b16 v[46:47], v23 offset:25600
    s_add_u32 m0, s28, 1024
    s_nop 0
    buffer_load_dwordx4 v15, s[16:19], s30 offen lds
    v_mfma_f32_32x32x16_bf16 v[96:111], v[60:63], v[48:51], v[96:111]
    s_add_u32 m0, s28, 2048
    s_nop 0
    buffer_load_dwordx4 v16, s[16:19], s30 offen lds
    s_add_u32 m0, s28, 3072
    s_nop 0
    buffer_load_dwordx4 v17, s[16:19], s30 offen lds
    v_mfma_f32_32x32x16_bf16 v[112:127], v[60:63], v[52:55], v[112:127]
    s_waitcnt lgkmcnt(0)
    v_mfma_f32_32x32x16_bf16 v[64:79], v[40:43], v[32:35], v[64:79]
    ds_read_b128 v[48:51], v21 offset:16384
    ds_read_b64_tr_b16 v[56:57], v22 offset:28672
    ds_read_b64_tr_b16 v[58:59], v22 offset:29696
    v_mfma_f32_32x32x16_bf16 v[80:95], v[40:43], v[36:39], v[80:95]
    ds_read_b128 v[52:55], v21 offset:20480
    ds_read_b64_tr_b16 v[60:61], v23 offset:28672
    ds_read_b64_tr_b16 v[62:63], v23 offset:29696
    v_mfma_f32_32x32x16_bf16 v[96:111], v[44:47], v[32:35], v[96:111]
    v_mfma_f32_32x32x16_bf16 v[112:127], v[44:47], v[36:39], v[112:127]
    s_waitcnt lgkmcnt(0)
    v_mfma_f32_32x32x16_bf16 v[64:79], v[56:59], v[48:51], v[64:79]
    s_waitcnt vmcnt(16)
    s_barrier
    ds_read_b128 v[32:35], v18 offset:32768
    ds_read_b64_tr_b16 v[40:41], v22 offset:32768
    ds_read_b64_tr_b16 v[42:43], v22 offset:33792
    v_mfma_f32_32x32x16_bf16 v[80:95], v[56:59], v[52:55], v[80:95]
    ds_read_b128 v[36:39], v18 offset:36864
    ds_read_b64_tr_b16 v[44:45], v23 offset:32768
    ds_read_b64_tr_b16 v[46:47], v23 offset:33792
    s_mov_b32 s29, 640
    s_mov_b32 s30, 1105920
    s_add_u32 m0, s27, 16384
    s_nop 0
    buffer_load_dwordx4 v10, s[12:15], s29 offen lds
    v_mfma_f32_32x32x16_bf16 v[96:111], v[60:63], v[48:51], v[96:111]
    s_add_u32 m0, s27, 17408
    s_nop 0
    buffer_load_dwordx4 v11, s[12:15], s29 offen lds
    v_mfma_f32_32x32x16_bf16 v[112:127], v[60:63], v[52:55], v[112:127]
    s_waitcnt lgkmcnt(0)
    v_mfma_f32_32x32x16_bf16 v[64:79], v[40:43], v[32:35], v[64:79]
    ds_read_b128 v[48:51], v19 offset:32768
    ds_read_b64_tr_b16 v[56:57], v22 offset:36864
    ds_read_b64_tr_b16 v[58:59], v22 offset:37888
    v_mfma_f32_32x32x16_bf16 v[80:95], v[40:43], v[36:39], v[80:95]
    ds_read_b128 v[52:55], v19 offset:36864
    ds_read_b64_tr_b16 v[60:61], v23 offset:36864
    ds_read_b64_tr_b16 v[62:63], v23 offset:37888
    s_add_u32 m0, s27, 18432
    s_nop 0
    buffer_load_dwordx4 v12, s[12:15], s29 offen lds
    v_mfma_f32_32x32x16_bf16 v[96:111], v[44:47], v[32:35], v[96:111]
    s_add_u32 m0, s27, 19456
    s_nop 0
    buffer_load_dwordx4 v13, s[12:15], s29 offen lds
    s_add_u32 m0, s28, 16384
    s_nop 0
    buffer_load_dwordx4 v14, s[16:19], s30 offen lds
    v_mfma_f32_32x32x16_bf16 v[112:127], v[44:47], v[36:39], v[112:127]
    s_waitcnt lgkmcnt(0)
    v_mfma_f32_32x32x16_bf16 v[64:79], v[56:59], v[48:51], v[64:79]
    ds_read_b128 v[32:35], v20 offset:32768
    ds_read_b64_tr_b16 v[40:41], v22 offset:40960
    ds_read_b64_tr_b16 v[42:43], v22 offset:41984
    v_mfma_f32_32x32x16_bf16 v[80:95], v[56:59], v[52:55], v[80:95]
    ds_read_b128 v[36:39], v20 offset:36864
    ds_read_b64_tr_b16 v[44:45], v23 offset:40960
    ds_read_b64_tr_b16 v[46:47], v23 offset:41984
    s_add_u32 m0, s28, 17408
    s_nop 0
    buffer_load_dwordx4 v15, s[16:19], s30 offen lds
    v_mfma_f32_32x32x16_bf16 v[96:111], v[60:63], v[48:51], v[96:111]
    s_add_u32 m0, s28, 18432
    s_nop 0
    buffer_load_dwordx4 v16, s[16:19], s30 offen lds
    s_add_u32 m0, s28, 19456
    s_nop 0
    buffer_load_dwordx4 v17, s[16:19], s30 offen lds
    v_mfma_f32_32x32x16_bf16 v[112:127], v[60:63], v[52:55], v[112:127]
    s_waitcnt lgkmcnt(0)
    v_mfma_f32_32x32x16_bf16 v[64:79], v[40:43], v[32:35], v[64:79]
    ds_read_b128 v[48:51], v21 offset:32768
    ds_read_b64_tr_b16 v[56:57], v22 offset:45056
    ds_read_b64_tr_b16 v[58:59], v22 offset:46080
    v_mfma_f32_32x32x16_bf16 v[80:95], v[40:43], v[36:39], v[80:95]
    ds_read_b128 v[52:55], v21 offset:36864
    ds_read_b64_tr_b16 v[60:61], v23 offset:45056
    ds_read_b64_tr_b16 v[62:63], v23 offset:46080
    v_mfma_f32_32x32x16_bf16 v[96:111], v[44:47], v[32:35], v[96:111]
    v_mfma_f32_32x32x16_bf16 v[112:127], v[44:47], v[36:39], v[112:127]
    s_waitcnt lgkmcnt(0)
    v_mfma_f32_32x32x16_bf16 v[64:79], v[56:59], v[48:51], v[64:79]
    s_waitcnt vmcnt(16)
    s_barrier
    ds_read_b128 v[32:35], v18 offset:49152
    ds_read_b64_tr_b16 v[40:41], v22 offset:49152
    ds_read_b64_tr_b16 v[42:43], v22 offset:50176
    v_mfma_f32_32x32x16_bf16 v[80:95], v[56:59], v[52:55], v[80:95]
    ds_read_b128 v[36:39], v18 offset:53248
    ds_read_b64_tr_b16 v[44:45], v23 offset:49152
    ds_read_b64_tr_b16 v[46:47], v23 offset:50176
    s_mov_b32 s29, 768
    s_mov_b32 s30, 1327104
    s_add_u32 m0, s27, 32768
    s_nop 0
    buffer_load_dwordx4 v10, s[12:15], s29 offen lds
    v_mfma_f32_32x32x16_bf16 v[96:111], v[60:63], v[48:51], v[96:111]
    s_add_u32 m0, s27, 33792
    s_nop 0
    buffer_load_dwordx4 v11, s[12:15], s29 offen lds
    v_mfma_f32_32x32x16_bf16 v[112:127], v[60:63], v[52:55], v[112:127]
    s_waitcnt lgkmcnt(0)
    v_mfma_f32_32x32x16_bf16 v[64:79], v[40:43], v[32:35], v[64:79]
    ds_read_b128 v[48:51], v19 offset:49152
    ds_read_b64_tr_b16 v[56:57], v22 offset:53248
    ds_read_b64_tr_b16 v[58:59], v22 offset:54272
    v_mfma_f32_32x32x16_bf16 v[80:95], v[40:43], v[36:39], v[80:95]
    ds_read_b128 v[52:55], v19 offset:53248
    ds_read_b64_tr_b16 v[60:61], v23 offset:53248
    ds_read_b64_tr_b16 v[62:63], v23 offset:54272
    s_add_u32 m0, s27, 34816
    s_nop 0
    buffer_load_dwordx4 v12, s[12:15], s29 offen lds
    v_mfma_f32_32x32x16_bf16 v[96:111], v[44:47], v[32:35], v[96:111]
    s_add_u32 m0, s27, 35840
    s_nop 0
    buffer_load_dwordx4 v13, s[12:15], s29 offen lds
    s_add_u32 m0, s28, 32768
    s_nop 0
    buffer_load_dwordx4 v14, s[16:19], s30 offen lds
    v_mfma_f32_32x32x16_bf16 v[112:127], v[44:47], v[36:39], v[112:127]
    s_waitcnt lgkmcnt(0)
    v_mfma_f32_32x32x16_bf16 v[64:79], v[56:59], v[48:51], v[64:79]
    ds_read_b128 v[32:35], v20 offset:49152
    ds_read_b64_tr_b16 v[40:41], v22 offset:57344
    ds_read_b64_tr_b16 v[42:43], v22 offset:58368
    v_mfma_f32_32x32x16_bf16 v[80:95], v[56:59], v[52:55], v[80:95]
    ds_read_b128 v[36:39], v20 offset:53248
    ds_read_b64_tr_b16 v[44:45], v23 offset:57344
    ds_read_b64_tr_b16 v[46:47], v23 offset:58368
    s_add_u32 m0, s28, 33792
    s_nop 0
    buffer_load_dwordx4 v15, s[16:19], s30 offen lds
    v_mfma_f32_32x32x16_bf16 v[96:111], v[60:63], v[48:51], v[96:111]
    s_add_u32 m0, s28, 34816
    s_nop 0
    buffer_load_dwordx4 v16, s[16:19], s30 offen lds
    s_add_u32 m0, s28, 35840
    s_nop 0
    buffer_load_dwordx4 v17, s[16:19], s30 offen lds
    v_mfma_f32_32x32x16_bf16 v[112:127], v[60:63], v[52:55], v[112:127]
    s_waitcnt lgkmcnt(0)
    v_mfma_f32_32x32x16_bf16 v[64:79], v[40:43], v[32:35], v[64:79]
    ds_read_b128 v[48:51], v21 offset:49152
    ds_read_b64_tr_b16 v[56:57], v22 offset:61440
    ds_read_b64_tr_b16 v[58:59], v22 offset:62464
    v_mfma_f32_32x32x16_bf16 v[80:95], v[40:43], v[36:39], v[80:95]
    ds_read_b128 v[52:55], v21 offset:53248
    ds_read_b64_tr_b16 v[60:61], v23 offset:61440
    ds_read_b64_tr_b16 v[62:63], v23 offset:62464
    v_mfma_f32_32x32x16_bf16 v[96:111], v[44:47], v[32:35], v[96:111]
    v_mfma_f32_32x32x16_bf16 v[112:127], v[44:47], v[36:39], v[112:127]
    s_waitcnt lgkmcnt(0)
    v_mfma_f32_32x32x16_bf16 v[64:79], v[56:59], v[48:51], v[64:79]
    s_waitcnt vmcnt(16)
    s_barrier
    ds_read_b128 v[32:35], v18 offset:0
    ds_read_b64_tr_b16 v[40:41], v22 offset:0
    ds_read_b64_tr_b16 v[42:43], v22 offset:1024
    v_mfma_f32_32x32x16_bf16 v[80:95], v[56:59], v[52:55], v[80:95]
    ds_read_b128 v[36:39], v18 offset:4096
    ds_read_b64_tr_b16 v[44:45], v23 offset:0
    ds_read_b64_tr_b16 v[46:47], v23 offset:1024
    s_mov_b32 s29, 896
    s_mov_b32 s30, 1548288
    s_add_u32 m0, s27, 49152
    s_nop 0
    buffer_load_dwordx4 v10, s[12:15], s29 offen lds
    v_mfma_f32_32x32x16_bf16 v[96:111], v[60:63], v[48:51], v[96:111]
    s_add_u32 m0, s27, 50176
    s_nop 0
    buffer_load_dwordx4 v11, s[12:15], s29 offen lds
    v_mfma_f32_32x32x16_bf16 v[112:127], v[60:63], v[52:55], v[112:127]
    s_waitcnt lgkmcnt(0)
    v_mfma_f32_32x32x16_bf16 v[64:79], v[40:43], v[32:35], v[64:79]
    ds_read_b128 v[48:51], v19 offset:0
    ds_read_b64_tr_b16 v[56:57], v22 offset:4096
    ds_read_b64_tr_b16 v[58:59], v22 offset:5120
    v_mfma_f32_32x32x16_bf16 v[80:95], v[40:43], v[36:39], v[80:95]
    ds_read_b128 v[52:55], v19 offset:4096
    ds_read_b64_tr_b16 v[60:61], v23 offset:4096
    ds_read_b64_tr_b16 v[62:63], v23 offset:5120
    s_add_u32 m0, s27, 51200
    s_nop 0
    buffer_load_dwordx4 v12, s[12:15], s29 offen lds
    v_mfma_f32_32x32x16_bf16 v[96:111], v[44:47], v[32:35], v[96:111]
    s_add_u32 m0, s27, 52224
    s_nop 0
    buffer_load_dwordx4 v13, s[12:15], s29 offen lds
    s_add_u32 m0, s28, 49152
    s_nop 0
    buffer_load_dwordx4 v14, s[16:19], s30 offen lds
    v_mfma_f32_32x32x16_bf16 v[112:127], v[44:47], v[36:39], v[112:127]
    s_waitcnt lgkmcnt(0)
    v_mfma_f32_32x32x16_bf16 v[64:79], v[56:59], v[48:51], v[64:79]
    ds_read_b128 v[32:35], v20 offset:0
    ds_read_b64_tr_b16 v[40:41], v22 offset:8192
    ds_read_b64_tr_b16 v[42:43], v22 offset:9216
    v_mfma_f32_32x32x16_bf16 v[80:95], v[56:59], v[52:55], v[80:95]
    ds_read_b128 v[36:39], v20 offset:4096
    ds_read_b64_tr_b16 v[44:45], v23 offset:8192
    ds_read_b64_tr_b16 v[46:47], v23 offset:9216
    s_add_u32 m0, s28, 50176
    s_nop 0
    buffer_load_dwordx4 v15, s[16:19], s30 offen lds
    v_mfma_f32_32x32x16_bf16 v[96:111], v[60:63], v[48:51], v[96:111]
    s_add_u32 m0, s28, 51200
    s_nop 0
    buffer_load_dwordx4 v16, s[16:19], s30 offen lds
    s_add_u32 m0, s28, 52224
    s_nop 0
    buffer_load_dwordx4 v17, s[16:19], s30 offen lds
    v_mfma_f32_32x32x16_bf16 v[112:127], v[60:63], v[52:55], v[112:127]
    s_waitcnt lgkmcnt(0)
    v_mfma_f32_32x32x16_bf16 v[64:79], v[40:43], v[32:35], v[64:79]
    ds_read_b128 v[48:51], v21 offset:0
    ds_read_b64_tr_b16 v[56:57], v22 offset:12288
    ds_read_b64_tr_b16 v[58:59], v22 offset:13312
    v_mfma_f32_32x32x16_bf16 v[80:95], v[40:43], v[36:39], v[80:95]
    ds_read_b128 v[52:55], v21 offset:4096
    ds_read_b64_tr_b16 v[60:61], v23 offset:12288
    ds_read_b64_tr_b16 v[62:63], v23 offset:13312
    v_mfma_f32_32x32x16_bf16 v[96:111], v[44:47], v[32:35], v[96:111]
    v_mfma_f32_32x32x16_bf16 v[112:127], v[44:47], v[36:39], v[112:127]
    s_waitcnt lgkmcnt(0)
    v_mfma_f32_32x32x16_bf16 v[64:79], v[56:59], v[48:51], v[64:79]
    s_waitcnt vmcnt(16)
    s_barrier
    ds_read_b128 v[32:35], v18 offset:16384
    ds_read_b64_tr_b16 v[40:41], v22 offset:16384
    ds_read_b64_tr_b16 v[42:43], v22 offset:17408
    v_mfma_f32_32x32x16_bf16 v[80:95], v[56:59], v[52:55], v[80:95]
    ds_read_b128 v[36:39], v18 offset:20480
    ds_read_b64_tr_b16 v[44:45], v23 offset:16384
    ds_read_b64_tr_b16 v[46:47], v23 offset:17408
    s_mov_b32 s29, 1024
    s_mov_b32 s30, 1769472
    s_add_u32 m0, s27, 0
    s_nop 0
    buffer_load_dwordx4 v10, s[12:15], s29 offen lds
    v_mfma_f32_32x32x16_bf16 v[96:111], v[60:63], v[48:51], v[96:111]
    s_add_u32 m0, s27, 1024
    s_nop 0
    buffer_load_dwordx4 v11, s[12:15], s29 offen lds
    v_mfma_f32_32x32x16_bf16 v[112:127], v[60:63], v[52:55], v[112:127]
    s_waitcnt lgkmcnt(0)
    v_mfma_f32_32x32x16_bf16 v[64:79], v[40:43], v[32:35], v[64:79]
    ds_read_b128 v[48:51], v19 offset:16384
    ds_read_b64_tr_b16 v[56:57], v22 offset:20480
    ds_read_b64_tr_b16 v[58:59], v22 offset:21504
    v_mfma_f32_32x32x16_bf16 v[80:95], v[40:43], v[36:39], v[80:95]
    ds_read_b128 v[52:55], v19 offset:20480
    ds_read_b64_tr_b16 v[60:61], v23 offset:20480
    ds_read_b64_tr_b16 v[62:63], v23 offset:21504
    s_add_u32 m0, s27, 2048
    s_nop 0
    buffer_load_dwordx4 v12, s[12:15], s29 offen lds
    v_mfma_f32_32x32x16_bf16 v[96:111], v[44:47], v[32:35], v[96:111]
    s_add_u32 m0, s27, 3072
    s_nop 0
    buffer_load_dwordx4 v13, s[12:15], s29 offen lds
    s_add_u32 m0, s28, 0
    s_nop 0
    buffer_load_dwordx4 v14, s[16:19], s30 offen lds
    v_mfma_f32_32x32x16_bf16 v[112:127], v[44:47], v[36:39], v[112:127]
    s_waitcnt lgkmcnt(0)
    v_mfma_f32_32x32x16_bf16 v[64:79], v[56:59], v[48:51], v[64:79]
    ds_read_b128 v[32:35], v20 offset:16384
    ds_read_b64_tr_b16 v[40:41], v22 offset:24576
    ds_read_b64_tr_b16 v[42:43], v22 offset:25600
    v_mfma_f32_32x32x16_bf16 v[80:95], v[56:59], v[52:55], v[80:95]
    ds_read_b128 v[36:39], v20 offset:20480
    ds_read_b64_tr_b16 v[44:45], v23 offset:24576
    ds_read_b64_tr_b16 v[46:47], v23 offset:25600
    s_add_u32 m0, s28, 1024
    s_nop 0
    buffer_load_dwordx4 v15, s[16:19], s30 offen lds
    v_mfma_f32_32x32x16_bf16 v[96:111], v[60:63], v[48:51], v[96:111]
    s_add_u32 m0, s28, 2048
    s_nop 0
    buffer_load_dwordx4 v16, s[16:19], s30 offen lds
    s_add_u32 m0, s28, 3072
    s_nop 0
    buffer_load_dwordx4 v17, s[16:19], s30 offen lds
    v_mfma_f32_32x32x16_bf16 v[112:127], v[60:63], v[52:55], v[112:127]
    s_waitcnt lgkmcnt(0)
    v_mfma_f32_32x32x16_bf16 v[64:79], v[40:43], v[32:35], v[64:79]
    ds_read_b128 v[48:51], v21 offset:16384
    ds_read_b64_tr_b16 v[56:57], v22 offset:28672
    ds_read_b64_tr_b16 v[58:59], v22 offset:29696
    v_mfma_f32_32x32x16_bf16 v[80:95], v[40:43], v[36:39], v[80:95]
    ds_read_b128 v[52:55], v21 offset:20480
    ds_read_b64_tr_b16 v[60:61], v23 offset:28672
    ds_read_b64_tr_b16 v[62:63], v23 offset:29696
    v_mfma_f32_32x32x16_bf16 v[96:111], v[44:47], v[32:35], v[96:111]
    v_mfma_f32_32x32x16_bf16 v[112:127], v[44:47], v[36:39], v[112:127]
    s_waitcnt lgkmcnt(0)
    v_mfma_f32_32x32x16_bf16 v[64:79], v[56:59], v[48:51], v[64:79]
    s_waitcnt vmcnt(16)
    s_barrier
    ds_read_b128 v[32:35], v18 offset:32768
    ds_read_b64_tr_b16 v[40:41], v22 offset:32768
    ds_read_b64_tr_b16 v[42:43], v22 offset:33792
    v_mfma_f32_32x32x16_bf16 v[80:95], v[56:59], v[52:55], v[80:95]
    ds_read_b128 v[36:39], v18 offset:36864
    ds_read_b64_tr_b16 v[44:45], v23 offset:32768
    ds_read_b64_tr_b16 v[46:47], v23 offset:33792
    s_mov_b32 s29, 1152
    s_mov_b32 s30, 1990656
    s_add_u32 m0, s27, 16384
    s_nop 0
    buffer_load_dwordx4 v10, s[12:15], s29 offen lds
    v_mfma_f32_32x32x16_bf16 v[96:111], v[60:63], v[48:51], v[96:111]
    s_add_u32 m0, s27, 17408
    s_nop 0
    buffer_load_dwordx4 v11, s[12:15], s29 offen lds
    v_mfma_f32_32x32x16_bf16 v[112:127], v[60:63], v[52:55], v[112:127]
    s_waitcnt lgkmcnt(0)
    v_mfma_f32_32x32x16_bf16 v[64:79], v[40:43], v[32:35], v[64:79]
    ds_read_b128 v[48:51], v19 offset:32768
    ds_read_b64_tr_b16 v[56:57], v22 offset:36864
    ds_read_b64_tr_b16 v[58:59], v22 offset:37888
    v_mfma_f32_32x32x16_bf16 v[80:95], v[40:43], v[36:39], v[80:95]
    ds_read_b128 v[52:55], v19 offset:36864
    ds_read_b64_tr_b16 v[60:61], v23 offset:36864
    ds_read_b64_tr_b16 v[62:63], v23 offset:37888
    s_add_u32 m0, s27, 18432
    s_nop 0
    buffer_load_dwordx4 v12, s[12:15], s29 offen lds
    v_mfma_f32_32x32x16_bf16 v[96:111], v[44:47], v[32:35], v[96:111]
    s_add_u32 m0, s27, 19456
    s_nop 0
    buffer_load_dwordx4 v13, s[12:15], s29 offen lds
    s_add_u32 m0, s28, 16384
    s_nop 0
    buffer_load_dwordx4 v14, s[16:19], s30 offen lds
    v_mfma_f32_32x32x16_bf16 v[112:127], v[44:47], v[36:39], v[112:127]
    s_waitcnt lgkmcnt(0)
    v_mfma_f32_32x32x16_bf16 v[64:79], v[56:59], v[48:51], v[64:79]
    ds_read_b128 v[32:35], v20 offset:32768
    ds_read_b64_tr_b16 v[40:41], v22 offset:40960
    ds_read_b64_tr_b16 v[42:43], v22 offset:41984
    v_mfma_f32_32x32x16_bf16 v[80:95], v[56:59], v[52:55], v[80:95]
    ds_read_b128 v[36:39], v20 offset:36864
    ds_read_b64_tr_b16 v[44:45], v23 offset:40960
    ds_read_b64_tr_b16 v[46:47], v23 offset:41984
    s_add_u32 m0, s28, 17408
    s_nop 0
    buffer_load_dwordx4 v15, s[16:19], s30 offen lds
    v_mfma_f32_32x32x16_bf16 v[96:111], v[60:63], v[48:51], v[96:111]
    s_add_u32 m0, s28, 18432
    s_nop 0
    buffer_load_dwordx4 v16, s[16:19], s30 offen lds
    s_add_u32 m0, s28, 19456
    s_nop 0
    buffer_load_dwordx4 v17, s[16:19], s30 offen lds
    v_mfma_f32_32x32x16_bf16 v[112:127], v[60:63], v[52:55], v[112:127]
    s_waitcnt lgkmcnt(0)
    v_mfma_f32_32x32x16_bf16 v[64:79], v[40:43], v[32:35], v[64:79]
    ds_read_b128 v[48:51], v21 offset:32768
    ds_read_b64_tr_b16 v[56:57], v22 offset:45056
    ds_read_b64_tr_b16 v[58:59], v22 offset:46080
    v_mfma_f32_32x32x16_bf16 v[80:95], v[40:43], v[36:39], v[80:95]
    ds_read_b128 v[52:55], v21 offset:36864
    ds_read_b64_tr_b16 v[60:61], v23 offset:45056
    ds_read_b64_tr_b16 v[62:63], v23 offset:46080
    v_mfma_f32_32x32x16_bf16 v[96:111], v[44:47], v[32:35], v[96:111]
    v_mfma_f32_32x32x16_bf16 v[112:127], v[44:47], v[36:39], v[112:127]
    s_waitcnt lgkmcnt(0)
    v_mfma_f32_32x32x16_bf16 v[64:79], v[56:59], v[48:51], v[64:79]
    s_waitcnt vmcnt(16)
    s_barrier
    ds_read_b128 v[32:35], v18 offset:49152
    ds_read_b64_tr_b16 v[40:41], v22 offset:49152
    ds_read_b64_tr_b16 v[42:43], v22 offset:50176
    v_mfma_f32_32x32x16_bf16 v[80:95], v[56:59], v[52:55], v[80:95]
    ds_read_b128 v[36:39], v18 offset:53248
    ds_read_b64_tr_b16 v[44:45], v23 offset:49152
    ds_read_b64_tr_b16 v[46:47], v23 offset:50176
    v_mfma_f32_32x32x16_bf16 v[96:111], v[60:63], v[48:51], v[96:111]
    v_mfma_f32_32x32x16_bf16 v[112:127], v[60:63], v[52:55], v[112:127]
    s_waitcnt lgkmcnt(0)
    v_mfma_f32_32x32x16_bf16 v[64:79], v[40:43], v[32:35], v[64:79]
    ds_read_b128 v[48:51], v19 offset:49152
    ds_read_b64_tr_b16 v[56:57], v22 offset:53248
    ds_read_b64_tr_b16 v[58:59], v22 offset:54272
    v_mfma_f32_32x32x16_bf16 v[80:95], v[40:43], v[36:39], v[80:95]
    ds_read_b128 v[52:55], v19 offset:53248
    ds_read_b64_tr_b16 v[60:61], v23 offset:53248
    ds_read_b64_tr_b16 v[62:63], v23 offset:54272
    v_mfma_f32_32x32x16_bf16 v[96:111], v[44:47], v[32:35], v[96:111]
    v_mfma_f32_32x32x16_bf16 v[112:127], v[44:47], v[36:39], v[112:127]
    s_waitcnt lgkmcnt(0)
    v_mfma_f32_32x32x16_bf16 v[64:79], v[56:59], v[48:51], v[64:79]
    ds_read_b128 v[32:35], v20 offset:49152
    ds_read_b64_tr_b16 v[40:41], v22 offset:57344
    ds_read_b64_tr_b16 v[42:43], v22 offset:58368
    v_mfma_f32_32x32x16_bf16 v[80:95], v[56:59], v[52:55], v[80:95]
    ds_read_b128 v[36:39], v20 offset:53248
    ds_read_b64_tr_b16 v[44:45], v23 offset:57344
    ds_read_b64_tr_b16 v[46:47], v23 offset:58368
    v_mfma_f32_32x32x16_bf16 v[96:111], v[60:63], v[48:51], v[96:111]
    v_mfma_f32_32x32x16_bf16 v[112:127], v[60:63], v[52:55], v[112:127]
    s_waitcnt lgkmcnt(0)
    v_mfma_f32_32x32x16_bf16 v[64:79], v[40:43], v[32:35], v[64:79]
    ds_read_b128 v[48:51], v21 offset:49152
    ds_read_b64_tr_b16 v[56:57], v22 offset:61440
    ds_read_b64_tr_b16 v[58:59], v22 offset:62464
    v_mfma_f32_32x32x16_bf16 v[80:95], v[40:43], v[36:39], v[80:95]
    ds_read_b128 v[52:55], v21 offset:53248
    ds_read_b64_tr_b16 v[60:61], v23 offset:61440
    ds_read_b64_tr_b16 v[62:63], v23 offset:62464
    v_mfma_f32_32x32x16_bf16 v[96:111], v[44:47], v[32:35], v[96:111]
    v_mfma_f32_32x32x16_bf16 v[112:127], v[44:47], v[36:39], v[112:127]
    s_waitcnt lgkmcnt(0)
    v_mfma_f32_32x32x16_bf16 v[64:79], v[56:59], v[48:51], v[64:79]
    s_waitcnt vmcnt(8)
    s_barrier
    ds_read_b128 v[32:35], v18 offset:0
    ds_read_b64_tr_b16 v[40:41], v22 offset:0
    ds_read_b64_tr_b16 v[42:43], v22 offset:1024
    v_mfma_f32_32x32x16_bf16 v[80:95], v[56:59], v[52:55], v[80:95]
    ds_read_b128 v[36:39], v18 offset:4096
    ds_read_b64_tr_b16 v[44:45], v23 offset:0
    ds_read_b64_tr_b16 v[46:47], v23 offset:1024
    v_mfma_f32_32x32x16_bf16 v[96:111], v[60:63], v[48:51], v[96:111]
    v_mfma_f32_32x32x16_bf16 v[112:127], v[60:63], v[52:55], v[112:127]
    s_waitcnt lgkmcnt(0)
    v_mfma_f32_32x32x16_bf16 v[64:79], v[40:43], v[32:35], v[64:79]
    ds_read_b128 v[48:51], v19 offset:0
    ds_read_b64_tr_b16 v[56:57], v22 offset:4096
    ds_read_b64_tr_b16 v[58:59], v22 offset:5120
    v_mfma_f32_32x32x16_bf16 v[80:95], v[40:43], v[36:39], v[80:95]
    ds_read_b128 v[52:55], v19 offset:4096
    ds_read_b64_tr_b16 v[60:61], v23 offset:4096
    ds_read_b64_tr_b16 v[62:63], v23 offset:5120
    v_mfma_f32_32x32x16_bf16 v[96:111], v[44:47], v[32:35], v[96:111]
    v_mfma_f32_32x32x16_bf16 v[112:127], v[44:47], v[36:39], v[112:127]
    s_waitcnt lgkmcnt(0)
    v_mfma_f32_32x32x16_bf16 v[64:79], v[56:59], v[48:51], v[64:79]
    ds_read_b128 v[32:35], v20 offset:0
    ds_read_b64_tr_b16 v[40:41], v22 offset:8192
    ds_read_b64_tr_b16 v[42:43], v22 offset:9216
    v_mfma_f32_32x32x16_bf16 v[80:95], v[56:59], v[52:55], v[80:95]
    ds_read_b128 v[36:39], v20 offset:4096
    ds_read_b64_tr_b16 v[44:45], v23 offset:8192
    ds_read_b64_tr_b16 v[46:47], v23 offset:9216
    v_mfma_f32_32x32x16_bf16 v[96:111], v[60:63], v[48:51], v[96:111]
    v_mfma_f32_32x32x16_bf16 v[112:127], v[60:63], v[52:55], v[112:127]
    s_waitcnt lgkmcnt(0)
    v_mfma_f32_32x32x16_bf16 v[64:79], v[40:43], v[32:35], v[64:79]
    ds_read_b128 v[48:51], v21 offset:0
    ds_read_b64_tr_b16 v[56:57], v22 offset:12288
    ds_read_b64_tr_b16 v[58:59], v22 offset:13312
    v_mfma_f32_32x32x16_bf16 v[80:95], v[40:43], v[36:39], v[80:95]
    ds_read_b128 v[52:55], v21 offset:4096
    ds_read_b64_tr_b16 v[60:61], v23 offset:12288
    ds_read_b64_tr_b16 v[62:63], v23 offset:13312
    v_mfma_f32_32x32x16_bf16 v[96:111], v[44:47], v[32:35], v[96:111]
    v_mfma_f32_32x32x16_bf16 v[112:127], v[44:47], v[36:39], v[112:127]
    s_waitcnt lgkmcnt(0)
    v_mfma_f32_32x32x16_bf16 v[64:79], v[56:59], v[48:51], v[64:79]
    s_waitcnt vmcnt(0)
    s_barrier
    ds_read_b128 v[32:35], v18 offset:16384
    ds_read_b64_tr_b16 v[40:41], v22 offset:16384
    ds_read_b64_tr_b16 v[42:43], v22 offset:17408
    v_mfma_f32_32x32x16_bf16 v[80:95], v[56:59], v[52:55], v[80:95]
    ds_read_b128 v[36:39], v18 offset:20480
    ds_read_b64_tr_b16 v[44:45], v23 offset:16384
    ds_read_b64_tr_b16 v[46:47], v23 offset:17408
    v_mfma_f32_32x32x16_bf16 v[96:111], v[60:63], v[48:51], v[96:111]
    v_mfma_f32_32x32x16_bf16 v[112:127], v[60:63], v[52:55], v[112:127]
    s_waitcnt lgkmcnt(0)
    v_mfma_f32_32x32x16_bf16 v[64:79], v[40:43], v[32:35], v[64:79]
    ds_read_b128 v[48:51], v19 offset:16384
    ds_read_b64_tr_b16 v[56:57], v22 offset:20480
    ds_read_b64_tr_b16 v[58:59], v22 offset:21504
    v_mfma_f32_32x32x16_bf16 v[80:95], v[40:43], v[36:39], v[80:95]
    ds_read_b128 v[52:55], v19 offset:20480
    ds_read_b64_tr_b16 v[60:61], v23 offset:20480
    ds_read_b64_tr_b16 v[62:63], v23 offset:21504
    v_mfma_f32_32x32x16_bf16 v[96:111], v[44:47], v[32:35], v[96:111]
    v_mfma_f32_32x32x16_bf16 v[112:127], v[44:47], v[36:39], v[112:127]
    s_waitcnt lgkmcnt(0)
    v_mfma_f32_32x32x16_bf16 v[64:79], v[56:59], v[48:51], v[64:79]
    ds_read_b128 v[32:35], v20 offset:16384
    ds_read_b64_tr_b16 v[40:41], v22 offset:24576
    ds_read_b64_tr_b16 v[42:43], v22 offset:25600
    v_mfma_f32_32x32x16_bf16 v[80:95], v[56:59], v[52:55], v[80:95]
    ds_read_b128 v[36:39], v20 offset:20480
    ds_read_b64_tr_b16 v[44:45], v23 offset:24576
    ds_read_b64_tr_b16 v[46:47], v23 offset:25600
    v_mfma_f32_32x32x16_bf16 v[96:111], v[60:63], v[48:51], v[96:111]
    v_mfma_f32_32x32x16_bf16 v[112:127], v[60:63], v[52:55], v[112:127]
    s_waitcnt lgkmcnt(0)
    v_mfma_f32_32x32x16_bf16 v[64:79], v[40:43], v[32:35], v[64:79]
    ds_read_b128 v[48:51], v21 offset:16384
    ds_read_b64_tr_b16 v[56:57], v22 offset:28672
    ds_read_b64_tr_b16 v[58:59], v22 offset:29696
    v_mfma_f32_32x32x16_bf16 v[80:95], v[40:43], v[36:39], v[80:95]
    ds_read_b128 v[52:55], v21 offset:20480
    ds_read_b64_tr_b16 v[60:61], v23 offset:28672
    ds_read_b64_tr_b16 v[62:63], v23 offset:29696
    v_mfma_f32_32x32x16_bf16 v[96:111], v[44:47], v[32:35], v[96:111]
    v_mfma_f32_32x32x16_bf16 v[112:127], v[44:47], v[36:39], v[112:127]
    s_waitcnt lgkmcnt(0)
    v_mfma_f32_32x32x16_bf16 v[64:79], v[56:59], v[48:51], v[64:79]
    v_mfma_f32_32x32x16_bf16 v[80:95], v[56:59], v[52:55], v[80:95]
    v_mfma_f32_32x32x16_bf16 v[96:111], v[60:63], v[48:51], v[96:111]
    v_mfma_f32_32x32x16_bf16 v[112:127], v[60:63], v[52:55], v[112:127]
    s_cmp_ge_u32 s40, s42
    s_cbranch_scc1 L1_end
    s_nop 7
    s_nop 7
    v_mov_b32 v26, 0xbfb8aa3b
    v_mov_b32 v27, 0xbfb8aa3b
    v_mov_b32 v28, 1.0
    v_mov_b32 v29, 1.0
    s_add_u32 s33, s32, 0
    v_cvt_pk_bf16_f32 v4, v64, v65
    v_cvt_pk_bf16_f32 v8, v66, v67
    v_and_b32 v3, 0xffff0000, v4
    v_lshlrev_b32 v2, 16, v4
    v_and_b32 v7, 0xffff0000, v8
    v_lshlrev_b32 v6, 16, v8
    v_pk_mul_f32 v[4:5], v[2:3], v[26:27]
    v_pk_mul_f32 v[8:9], v[6:7], v[26:27]
    v_exp_f32 v4, v4
    v_exp_f32 v5, v5
    v_exp_f32 v8, v8
    v_exp_f32 v9, v9
    v_pk_add_f32 v[4:5], v[4:5], v[28:29]
    v_pk_add_f32 v[8:9], v[8:9], v[28:29]
    v_rcp_f32 v4, v4
    v_rcp_f32 v5, v5
    v_rcp_f32 v8, v8
    v_rcp_f32 v9, v9
    v_pk_mul_f32 v[2:3], v[2:3], v[4:5]
    v_pk_mul_f32 v[6:7], v[6:7], v[8:9]
    v_cvt_pk_bf16_f32 v32, v2, v3
    v_cvt_pk_bf16_f32 v33, v6, v7
    v_cvt_pk_bf16_f32 v4, v68, v69
    v_cvt_pk_bf16_f32 v8, v70, v71
    v_and_b32 v3, 0xffff0000, v4
    v_lshlrev_b32 v2, 16, v4
    v_and_b32 v7, 0xffff0000, v8
    v_lshlrev_b32 v6, 16, v8
    v_pk_mul_f32 v[4:5], v[2:3], v[26:27]
    v_pk_mul_f32 v[8:9], v[6:7], v[26:27]
    v_exp_f32 v4, v4
    v_exp_f32 v5, v5
    v_exp_f32 v8, v8
    v_exp_f32 v9, v9
    v_pk_add_f32 v[4:5], v[4:5], v[28:29]
    v_pk_add_f32 v[8:9], v[8:9], v[28:29]
    v_rcp_f32 v4, v4
    v_rcp_f32 v5, v5
    v_rcp_f32 v8, v8
    v_rcp_f32 v9, v9
    v_pk_mul_f32 v[2:3], v[2:3], v[4:5]
    v_pk_mul_f32 v[6:7], v[6:7], v[8:9]
    v_cvt_pk_bf16_f32 v34, v2, v3
    v_cvt_pk_bf16_f32 v35, v6, v7
    v_cvt_pk_bf16_f32 v4, v72, v73
    v_cvt_pk_bf16_f32 v8, v74, v75
    v_and_b32 v3, 0xffff0000, v4
    v_lshlrev_b32 v2, 16, v4
    v_and_b32 v7, 0xffff0000, v8
    v_lshlrev_b32 v6, 16, v8
    v_pk_mul_f32 v[4:5], v[2:3], v[26:27]
    v_pk_mul_f32 v[8:9], v[6:7], v[26:27]
    v_exp_f32 v4, v4
    v_exp_f32 v5, v5
    v_exp_f32 v8, v8
    v_exp_f32 v9, v9
    v_pk_add_f32 v[4:5], v[4:5], v[28:29]
    v_pk_add_f32 v[8:9], v[8:9], v[28:29]
    v_rcp_f32 v4, v4
    v_rcp_f32 v5, v5
    v_rcp_f32 v8, v8
    v_rcp_f32 v9, v9
    v_pk_mul_f32 v[2:3], v[2:3], v[4:5]
    v_pk_mul_f32 v[6:7], v[6:7], v[8:9]
    v_cvt_pk_bf16_f32 v36, v2, v3
    v_cvt_pk_bf16_f32 v37, v6, v7
    v_cvt_pk_bf16_f32 v4, v76, v77
    v_cvt_pk_bf16_f32 v8, v78, v79
    v_and_b32 v3, 0xffff0000, v4
    v_lshlrev_b32 v2, 16, v4
    v_and_b32 v7, 0xffff0000, v8
    v_lshlrev_b32 v6, 16, v8
    v_pk_mul_f32 v[4:5], v[2:3], v[26:27]
    v_pk_mul_f32 v[8:9], v[6:7], v[26:27]
    v_exp_f32 v4, v4
    v_exp_f32 v5, v5
    v_exp_f32 v8, v8
    v_exp_f32 v9, v9
    v_pk_add_f32 v[4:5], v[4:5], v[28:29]
    v_pk_add_f32 v[8:9], v[8:9], v[28:29]
    v_rcp_f32 v4, v4
    v_rcp_f32 v5, v5
    v_rcp_f32 v8, v8
    v_rcp_f32 v9, v9
    v_pk_mul_f32 v[2:3], v[2:3], v[4:5]
    v_pk_mul_f32 v[6:7], v[6:7], v[8:9]
    v_cvt_pk_bf16_f32 v38, v2, v3
    v_cvt_pk_bf16_f32 v39, v6, v7
    buffer_store_dwordx4 v[32:35], v24, s[20:23], s33 offen offset:0
    buffer_store_dwordx4 v[36:39], v24, s[20:23], s33 offen offset:512
    v_cvt_pk_bf16_f32 v4, v80, v81
    v_cvt_pk_bf16_f32 v8, v82, v83
    v_and_b32 v3, 0xffff0000, v4
    v_lshlrev_b32 v2, 16, v4
    v_and_b32 v7, 0xffff0000, v8
    v_lshlrev_b32 v6, 16, v8
    v_pk_mul_f32 v[4:5], v[2:3], v[26:27]
    v_pk_mul_f32 v[8:9], v[6:7], v[26:27]
    v_exp_f32 v4, v4
    v_exp_f32 v5, v5
    v_exp_f32 v8, v8
    v_exp_f32 v9, v9
    v_pk_add_f32 v[4:5], v[4:5], v[28:29]
    v_pk_add_f32 v[8:9], v[8:9], v[28:29]
    v_rcp_f32 v4, v4
    v_rcp_f32 v5, v5
    v_rcp_f32 v8, v8
    v_rcp_f32 v9, v9
    v_pk_mul_f32 v[2:3], v[2:3], v[4:5]
    v_pk_mul_f32 v[6:7], v[6:7], v[8:9]
    v_cvt_pk_bf16_f32 v40, v2, v3
    v_cvt_pk_bf16_f32 v41, v6, v7
    v_cvt_pk_bf16_f32 v4, v84, v85
    v_cvt_pk_bf16_f32 v8, v86, v87
    v_and_b32 v3, 0xffff0000, v4
    v_lshlrev_b32 v2, 16, v4
    v_and_b32 v7, 0xffff0000, v8
    v_lshlrev_b32 v6, 16, v8
    v_pk_mul_f32 v[4:5], v[2:3], v[26:27]
    v_pk_mul_f32 v[8:9], v[6:7], v[26:27]
    v_exp_f32 v4, v4
    v_exp_f32 v5, v5
    v_exp_f32 v8, v8
    v_exp_f32 v9, v9
    v_pk_add_f32 v[4:5], v[4:5], v[28:29]
    v_pk_add_f32 v[8:9], v[8:9], v[28:29]
    v_rcp_f32 v4, v4
    v_rcp_f32 v5, v5
    v_rcp_f32 v8, v8
    v_rcp_f32 v9, v9
    v_pk_mul_f32 v[2:3], v[2:3], v[4:5]
    v_pk_mul_f32 v[6:7], v[6:7], v[8:9]
    v_cvt_pk_bf16_f32 v42, v2, v3
    v_cvt_pk_bf16_f32 v43, v6, v7
    v_cvt_pk_bf16_f32 v4, v88, v89
    v_cvt_pk_bf16_f32 v8, v90, v91
    v_and_b32 v3, 0xffff0000, v4
    v_lshlrev_b32 v2, 16, v4
    v_and_b32 v7, 0xffff0000, v8
    v_lshlrev_b32 v6, 16, v8
    v_pk_mul_f32 v[4:5], v[2:3], v[26:27]
    v_pk_mul_f32 v[8:9], v[6:7], v[26:27]
    v_exp_f32 v4, v4
    v_exp_f32 v5, v5
    v_exp_f32 v8, v8
    v_exp_f32 v9, v9
    v_pk_add_f32 v[4:5], v[4:5], v[28:29]
    v_pk_add_f32 v[8:9], v[8:9], v[28:29]
    v_rcp_f32 v4, v4
    v_rcp_f32 v5, v5
    v_rcp_f32 v8, v8
    v_rcp_f32 v9, v9
    v_pk_mul_f32 v[2:3], v[2:3], v[4:5]
    v_pk_mul_f32 v[6:7], v[6:7], v[8:9]
    v_cvt_pk_bf16_f32 v44, v2, v3
    v_cvt_pk_bf16_f32 v45, v6, v7
    v_cvt_pk_bf16_f32 v4, v92, v93
    v_cvt_pk_bf16_f32 v8, v94, v95
    v_and_b32 v3, 0xffff0000, v4
    v_lshlrev_b32 v2, 16, v4
    v_and_b32 v7, 0xffff0000, v8
    v_lshlrev_b32 v6, 16, v8
    v_pk_mul_f32 v[4:5], v[2:3], v[26:27]
    v_pk_mul_f32 v[8:9], v[6:7], v[26:27]
    v_exp_f32 v4, v4
    v_exp_f32 v5, v5
    v_exp_f32 v8, v8
    v_exp_f32 v9, v9
    v_pk_add_f32 v[4:5], v[4:5], v[28:29]
    v_pk_add_f32 v[8:9], v[8:9], v[28:29]
    v_rcp_f32 v4, v4
    v_rcp_f32 v5, v5
    v_rcp_f32 v8, v8
    v_rcp_f32 v9, v9
    v_pk_mul_f32 v[2:3], v[2:3], v[4:5]
    v_pk_mul_f32 v[6:7], v[6:7], v[8:9]
    v_cvt_pk_bf16_f32 v46, v2, v3
    v_cvt_pk_bf16_f32 v47, v6, v7
    buffer_store_dwordx4 v[40:43], v24, s[20:23], s33 offen offset:2048
    buffer_store_dwordx4 v[44:47], v24, s[20:23], s33 offen offset:2560
    s_add_u32 s41, s40, 32
    s_cmp_ge_u32 s41, s42
    s_cbranch_scc1 L1_fin
    s_add_u32 s33, s32, 4096
    v_cvt_pk_bf16_f32 v4, v96, v97
    v_cvt_pk_bf16_f32 v8, v98, v99
    v_and_b32 v3, 0xffff0000, v4
    v_lshlrev_b32 v2, 16, v4
    v_and_b32 v7, 0xffff0000, v8
    v_lshlrev_b32 v6, 16, v8
    v_pk_mul_f32 v[4:5], v[2:3], v[26:27]
    v_pk_mul_f32 v[8:9], v[6:7], v[26:27]
    v_exp_f32 v4, v4
    v_exp_f32 v5, v5
    v_exp_f32 v8, v8
    v_exp_f32 v9, v9
    v_pk_add_f32 v[4:5], v[4:5], v[28:29]
    v_pk_add_f32 v[8:9], v[8:9], v[28:29]
    v_rcp_f32 v4, v4
    v_rcp_f32 v5, v5
    v_rcp_f32 v8, v8
    v_rcp_f32 v9, v9
    v_pk_mul_f32 v[2:3], v[2:3], v[4:5]
    v_pk_mul_f32 v[6:7], v[6:7], v[8:9]
    v_cvt_pk_bf16_f32 v48, v2, v3
    v_cvt_pk_bf16_f32 v49, v6, v7
    v_cvt_pk_bf16_f32 v4, v100, v101
    v_cvt_pk_bf16_f32 v8, v102, v103
    v_and_b32 v3, 0xffff0000, v4
    v_lshlrev_b32 v2, 16, v4
    v_and_b32 v7, 0xffff0000, v8
    v_lshlrev_b32 v6, 16, v8
    v_pk_mul_f32 v[4:5], v[2:3], v[26:27]
    v_pk_mul_f32 v[8:9], v[6:7], v[26:27]
    v_exp_f32 v4, v4
    v_exp_f32 v5, v5
    v_exp_f32 v8, v8
    v_exp_f32 v9, v9
    v_pk_add_f32 v[4:5], v[4:5], v[28:29]
    v_pk_add_f32 v[8:9], v[8:9], v[28:29]
    v_rcp_f32 v4, v4
    v_rcp_f32 v5, v5
    v_rcp_f32 v8, v8
    v_rcp_f32 v9, v9
    v_pk_mul_f32 v[2:3], v[2:3], v[4:5]
    v_pk_mul_f32 v[6:7], v[6:7], v[8:9]
    v_cvt_pk_bf16_f32 v50, v2, v3
    v_cvt_pk_bf16_f32 v51, v6, v7
    v_cvt_pk_bf16_f32 v4, v104, v105
    v_cvt_pk_bf16_f32 v8, v106, v107
    v_and_b32 v3, 0xffff0000, v4
    v_lshlrev_b32 v2, 16, v4
    v_and_b32 v7, 0xffff0000, v8
    v_lshlrev_b32 v6, 16, v8
    v_pk_mul_f32 v[4:5], v[2:3], v[26:27]
    v_pk_mul_f32 v[8:9], v[6:7], v[26:27]
    v_exp_f32 v4, v4
    v_exp_f32 v5, v5
    v_exp_f32 v8, v8
    v_exp_f32 v9, v9
    v_pk_add_f32 v[4:5], v[4:5], v[28:29]
    v_pk_add_f32 v[8:9], v[8:9], v[28:29]
    v_rcp_f32 v4, v4
    v_rcp_f32 v5, v5
    v_rcp_f32 v8, v8
    v_rcp_f32 v9, v9
    v_pk_mul_f32 v[2:3], v[2:3], v[4:5]
    v_pk_mul_f32 v[6:7], v[6:7], v[8:9]
    v_cvt_pk_bf16_f32 v52, v2, v3
    v_cvt_pk_bf16_f32 v53, v6, v7
    v_cvt_pk_bf16_f32 v4, v108, v109
    v_cvt_pk_bf16_f32 v8, v110, v111
    v_and_b32 v3, 0xffff0000, v4
    v_lshlrev_b32 v2, 16, v4
    v_and_b32 v7, 0xffff0000, v8
    v_lshlrev_b32 v6, 16, v8
    v_pk_mul_f32 v[4:5], v[2:3], v[26:27]
    v_pk_mul_f32 v[8:9], v[6:7], v[26:27]
    v_exp_f32 v4, v4
    v_exp_f32 v5, v5
    v_exp_f32 v8, v8
    v_exp_f32 v9, v9
    v_pk_add_f32 v[4:5], v[4:5], v[28:29]
    v_pk_add_f32 v[8:9], v[8:9], v[28:29]
    v_rcp_f32 v4, v4
    v_rcp_f32 v5, v5
    v_rcp_f32 v8, v8
    v_rcp_f32 v9, v9
    v_pk_mul_f32 v[2:3], v[2:3], v[4:5]
    v_pk_mul_f32 v[6:7], v[6:7], v[8:9]
    v_cvt_pk_bf16_f32 v54, v2, v3
    v_cvt_pk_bf16_f32 v55, v6, v7
    buffer_store_dwordx4 v[48:51], v24, s[20:23], s33 offen offset:0
    buffer_store_dwordx4 v[52:55], v24, s[20:23], s33 offen offset:512
    v_cvt_pk_bf16_f32 v4, v112, v113
    v_cvt_pk_bf16_f32 v8, v114, v115
    v_and_b32 v3, 0xffff0000, v4
    v_lshlrev_b32 v2, 16, v4
    v_and_b32 v7, 0xffff0000, v8
    v_lshlrev_b32 v6, 16, v8
    v_pk_mul_f32 v[4:5], v[2:3], v[26:27]
    v_pk_mul_f32 v[8:9], v[6:7], v[26:27]
    v_exp_f32 v4, v4
    v_exp_f32 v5, v5
    v_exp_f32 v8, v8
    v_exp_f32 v9, v9
    v_pk_add_f32 v[4:5], v[4:5], v[28:29]
    v_pk_add_f32 v[8:9], v[8:9], v[28:29]
    v_rcp_f32 v4, v4
    v_rcp_f32 v5, v5
    v_rcp_f32 v8, v8
    v_rcp_f32 v9, v9
    v_pk_mul_f32 v[2:3], v[2:3], v[4:5]
    v_pk_mul_f32 v[6:7], v[6:7], v[8:9]
    v_cvt_pk_bf16_f32 v56, v2, v3
    v_cvt_pk_bf16_f32 v57, v6, v7
    v_cvt_pk_bf16_f32 v4, v116, v117
    v_cvt_pk_bf16_f32 v8, v118, v119
    v_and_b32 v3, 0xffff0000, v4
    v_lshlrev_b32 v2, 16, v4
    v_and_b32 v7, 0xffff0000, v8
    v_lshlrev_b32 v6, 16, v8
    v_pk_mul_f32 v[4:5], v[2:3], v[26:27]
    v_pk_mul_f32 v[8:9], v[6:7], v[26:27]
    v_exp_f32 v4, v4
    v_exp_f32 v5, v5
    v_exp_f32 v8, v8
    v_exp_f32 v9, v9
    v_pk_add_f32 v[4:5], v[4:5], v[28:29]
    v_pk_add_f32 v[8:9], v[8:9], v[28:29]
    v_rcp_f32 v4, v4
    v_rcp_f32 v5, v5
    v_rcp_f32 v8, v8
    v_rcp_f32 v9, v9
    v_pk_mul_f32 v[2:3], v[2:3], v[4:5]
    v_pk_mul_f32 v[6:7], v[6:7], v[8:9]
    v_cvt_pk_bf16_f32 v58, v2, v3
    v_cvt_pk_bf16_f32 v59, v6, v7
    v_cvt_pk_bf16_f32 v4, v120, v121
    v_cvt_pk_bf16_f32 v8, v122, v123
    v_and_b32 v3, 0xffff0000, v4
    v_lshlrev_b32 v2, 16, v4
    v_and_b32 v7, 0xffff0000, v8
    v_lshlrev_b32 v6, 16, v8
    v_pk_mul_f32 v[4:5], v[2:3], v[26:27]
    v_pk_mul_f32 v[8:9], v[6:7], v[26:27]
    v_exp_f32 v4, v4
    v_exp_f32 v5, v5
    v_exp_f32 v8, v8
    v_exp_f32 v9, v9
    v_pk_add_f32 v[4:5], v[4:5], v[28:29]
    v_pk_add_f32 v[8:9], v[8:9], v[28:29]
    v_rcp_f32 v4, v4
    v_rcp_f32 v5, v5
    v_rcp_f32 v8, v8
    v_rcp_f32 v9, v9
    v_pk_mul_f32 v[2:3], v[2:3], v[4:5]
    v_pk_mul_f32 v[6:7], v[6:7], v[8:9]
    v_cvt_pk_bf16_f32 v60, v2, v3
    v_cvt_pk_bf16_f32 v61, v6, v7
    v_cvt_pk_bf16_f32 v4, v124, v125
    v_cvt_pk_bf16_f32 v8, v126, v127
    v_and_b32 v3, 0xffff0000, v4
    v_lshlrev_b32 v2, 16, v4
    v_and_b32 v7, 0xffff0000, v8
    v_lshlrev_b32 v6, 16, v8
    v_pk_mul_f32 v[4:5], v[2:3], v[26:27]
    v_pk_mul_f32 v[8:9], v[6:7], v[26:27]
    v_exp_f32 v4, v4
    v_exp_f32 v5, v5
    v_exp_f32 v8, v8
    v_exp_f32 v9, v9
    v_pk_add_f32 v[4:5], v[4:5], v[28:29]
    v_pk_add_f32 v[8:9], v[8:9], v[28:29]
    v_rcp_f32 v4, v4
    v_rcp_f32 v5, v5
    v_rcp_f32 v8, v8
    v_rcp_f32 v9, v9
    v_pk_mul_f32 v[2:3], v[2:3], v[4:5]
    v_pk_mul_f32 v[6:7], v[6:7], v[8:9]
    v_cvt_pk_bf16_f32 v62, v2, v3
    v_cvt_pk_bf16_f32 v63, v6, v7
    buffer_store_dwordx4 v[56:59], v24, s[20:23], s33 offen offset:2048
    buffer_store_dwordx4 v[60:63], v24, s[20:23], s33 offen offset:2560
L1_fin:
    s_waitcnt vmcnt(0)
L1_end:
    s_endpgm
L1_helper:
    s_cmp_ge_u32 s2, 256
    s_cbranch_scc1 L1_end
    s_load_dwordx2 s[4:5], s[0:1], 16
    s_load_dwordx2 s[8:9], s[0:1], 40
    v_and_b32 v1, 63, v0
    v_lshrrev_b32 v2, 6, v0
    s_nop 0
    v_readfirstlane_b32 s24, v2
    s_sub_u32 s25, s2, 224
    v_lshlrev_b32 v10, 4, v1
    v_add_u32 v11, 4096, v10
    v_lshrrev_b32 v2, 4, v1
    v_and_b32 v3, 15, v1
    v_lshrrev_b32 v4, 2, v3
    v_and_b32 v3, 3, v3
    v_lshrrev_b32 v5, 1, v2
    v_lshlrev_b32 v5, 4, v5
    v_and_b32 v6, 1, v2
    v_lshlrev_b32 v6, 2, v6
    v_add_u32 v5, v5, v6
    v_add_u32 v5, v5, v4
    v_mul_u32_u24 v5, 1280, v5
    v_lshlrev_b32 v3, 3, v3
    v_add_u32 v5, v5, v3
    s_mul_i32 s26, s24, 320
    v_add_u32 v16, s26, v5
    s_mul_i32 s27, s24, 10240
    s_waitcnt lgkmcnt(0)
    s_mov_b32 s16, s4
    s_and_b32 s17, s5, 0xffff
    s_mov_b32 s18, 2211840
    s_mov_b32 s19, 0x20000
    s_add_u32 s20, s8, 0x800000
    s_addc_u32 s21, s9, 0
    s_and_b32 s21, s21, 0xffff
    s_mov_b32 s22, 2211840
    s_mov_b32 s23, 0x20000
L1_hloop:
    s_mul_i32 s28, s25, 40960
    s_add_u32 s28, s28, s27
    s_add_u32 m0, s27, 0
    s_add_u32 s29, s28, 0
    buffer_load_dwordx4 v10, s[16:19], s29 offen lds
    s_add_u32 m0, s27, 1024
    s_add_u32 s29, s28, 1024
    buffer_load_dwordx4 v10, s[16:19], s29 offen lds
    s_add_u32 m0, s27, 2048
    s_add_u32 s29, s28, 2048
    buffer_load_dwordx4 v10, s[16:19], s29 offen lds
    s_add_u32 m0, s27, 3072
    s_add_u32 s29, s28, 3072
    buffer_load_dwordx4 v10, s[16:19], s29 offen lds
    s_add_u32 m0, s27, 4096
    s_add_u32 s29, s28, 4096
    buffer_load_dwordx4 v10, s[16:19], s29 offen lds
    s_add_u32 m0, s27, 5120
    s_add_u32 s29, s28, 5120
    buffer_load_dwordx4 v10, s[16:19], s29 offen lds
    s_add_u32 m0, s27, 6144
    s_add_u32 s29, s28, 6144
    buffer_load_dwordx4 v10, s[16:19], s29 offen lds
    s_add_u32 m0, s27, 7168
    s_add_u32 s29, s28, 7168
    buffer_load_dwordx4 v10, s[16:19], s29 offen lds
    s_add_u32 m0, s27, 8192
    s_add_u32 s29, s28, 8192
    buffer_load_dwordx4 v10, s[16:19], s29 offen lds
    s_add_u32 m0, s27, 9216
    s_add_u32 s29, s28, 9216
    buffer_load_dwordx4 v10, s[16:19], s29 offen lds
    s_waitcnt vmcnt(0)
    s_barrier
    ds_read_b64_tr_b16 v[32:33], v16 offset:0
    ds_read_b64_tr_b16 v[34:35], v16 offset:10240
    ds_read_b64_tr_b16 v[36:37], v16 offset:32
    ds_read_b64_tr_b16 v[38:39], v16 offset:10272
    ds_read_b64_tr_b16 v[40:41], v16 offset:64
    ds_read_b64_tr_b16 v[42:43], v16 offset:10304
    ds_read_b64_tr_b16 v[44:45], v16 offset:96
    ds_read_b64_tr_b16 v[46:47], v16 offset:10336
    ds_read_b64_tr_b16 v[48:49], v16 offset:128
    ds_read_b64_tr_b16 v[50:51], v16 offset:10368
    ds_read_b64_tr_b16 v[52:53], v16 offset:160
    ds_read_b64_tr_b16 v[54:55], v16 offset:10400
    ds_read_b64_tr_b16 v[56:57], v16 offset:192
    ds_read_b64_tr_b16 v[58:59], v16 offset:10432
    ds_read_b64_tr_b16 v[60:61], v16 offset:224
    ds_read_b64_tr_b16 v[62:63], v16 offset:10464
    ds_read_b64_tr_b16 v[64:65], v16 offset:256
    ds_read_b64_tr_b16 v[66:67], v16 offset:10496
    ds_read_b64_tr_b16 v[68:69], v16 offset:288
    ds_read_b64_tr_b16 v[70:71], v16 offset:10528
    s_lshl_b32 s30, s24, 1
    s_mul_i32 s30, s30, 54
    s_add_u32 s30, s30, s25
    s_mul_i32 s30, s30, 5120
    s_add_u32 s31, s30, 276480
    s_waitcnt lgkmcnt(0)
    s_barrier
    buffer_store_dwordx4 v[32:35], v10, s[20:23], s30 offen offset:0
    buffer_store_dwordx4 v[36:39], v10, s[20:23], s30 offen offset:1024
    buffer_store_dwordx4 v[40:43], v10, s[20:23], s30 offen offset:2048
    buffer_store_dwordx4 v[44:47], v10, s[20:23], s30 offen offset:3072
    buffer_store_dwordx4 v[48:51], v11, s[20:23], s30 offen
    buffer_store_dwordx4 v[52:55], v10, s[20:23], s31 offen offset:0
    buffer_store_dwordx4 v[56:59], v10, s[20:23], s31 offen offset:1024
    buffer_store_dwordx4 v[60:63], v10, s[20:23], s31 offen offset:2048
    buffer_store_dwordx4 v[64:67], v10, s[20:23], s31 offen offset:3072
    buffer_store_dwordx4 v[68:71], v11, s[20:23], s31 offen
    s_add_u32 s25, s25, 32
    s_cmp_lt_u32 s25, 54
    s_cbranch_scc1 L1_hloop
    s_waitcnt vmcnt(0)
    s_endpgm
.globl ffn2_kernel
.p2align 8
.type ffn2_kernel,@function
ffn2_kernel:
    s_cmp_ge_u32 s2, 256
    s_cbranch_scc1 L2_end
    s_load_dwordx2 s[6:7], s[0:1], 24
    s_load_dwordx2 s[8:9], s[0:1], 40
    v_and_b32 v1, 63, v0
    v_lshrrev_b32 v2, 6, v0
    s_nop 0
    v_readfirstlane_b32 s24, v2
    s_and_b32 s31, s2, 7
    s_lshr_b32 s33, s2, 3
    s_and_b32 s34, s33, 7
    s_lshr_b32 s35, s33, 3
    s_lshr_b32 s25, s31, 1
    s_lshl_b32 s25, s25, 9
    s_lshl_b32 s34, s34, 6
    s_add_u32 s25, s25, s34
    s_and_b32 s31, s31, 1
    s_lshl_b32 s31, s31, 2
    s_add_u32 s35, s35, s31
    s_mul_i32 s26, s35, 80
    s_mul_i32 s27, s24, 21504
    s_lshl_b32 s36, s24, 12
    s_mul_i32 s37, s24, 5120
    v_lshlrev_b32 v10, 4, v1
    v_add_u32 v11, 4096, v10
    s_lshr_b32 s39, s25, 6
    s_mul_i32 s39, s39, 221184
    s_mul_i32 s40, s35, 276480
    s_add_u32 s40, s40, 0x800000
    s_waitcnt lgkmcnt(0)
    s_add_u32 s12, s8, s39
    s_addc_u32 s13, s9, 0
    s_and_b32 s13, s13, 0xffff
    s_mov_b32 s14, 221184
    s_mov_b32 s15, 0x20000
    s_add_u32 s16, s8, s40
    s_addc_u32 s17, s9, 0
    s_and_b32 s17, s17, 0xffff
    s_mov_b32 s18, 276480
    s_mov_b32 s19, 0x20000
    s_add_u32 s41, s24, 0
    s_and_b32 s41, s41, 3
    s_lshl_b32 s41, s41, 10
    s_add_u32 s41, s41, s36
    s_add_u32 s42, s24, 1
    s_and_b32 s42, s42, 3
    s_lshl_b32 s42, s42, 10
    s_add_u32 s42, s42, s36
    s_add_u32 s43, s24, 2
    s_and_b32 s43, s43, 3
    s_lshl_b32 s43, s43, 10
    s_add_u32 s43, s43, s36
    s_add_u32 s44, s24, 3
    s_and_b32 s44, s44, 3
    s_lshl_b32 s44, s44, 10
    s_add_u32 s44, s44, s36
    s_add_u32 s29, s37, 0
    buffer_load_dwordx4 v[48:51], v10, s[16:19], s29 offen offset:0
    buffer_load_dwordx4 v[52:55], v10, s[16:19], s29 offen offset:1024
    buffer_load_dwordx4 v[56:59], v10, s[16:19], s29 offen offset:2048
    buffer_load_dwordx4 v[60:63], v10, s[16:19], s29 offen offset:3072
    buffer_load_dwordx4 v[64:67], v11, s[16:19], s29 offen
    s_add_u32 s28, s41, 0
    buffer_load_dwordx4 v[32:35], v10, s[12:15], s28 offen
    s_add_u32 s28, s42, 0
    buffer_load_dwordx4 v[36:39], v10, s[12:15], s28 offen
    s_add_u32 s28, s43, 0
    buffer_load_dwordx4 v[40:43], v10, s[12:15], s28 offen
    s_add_u32 s28, s44, 0
    buffer_load_dwordx4 v[44:47], v10, s[12:15], s28 offen
    s_add_u32 s29, s37, 20480
    buffer_load_dwordx4 v[84:87], v10, s[16:19], s29 offen offset:0
    buffer_load_dwordx4 v[88:91], v10, s[16:19], s29 offen offset:1024
    buffer_load_dwordx4 v[92:95], v10, s[16:19], s29 offen offset:2048
    buffer_load_dwordx4 v[96:99], v10, s[16:19], s29 offen offset:3072
    buffer_load_dwordx4 v[100:103], v11, s[16:19], s29 offen
    s_add_u32 s28, s41, 16384
    buffer_load_dwordx4 v[68:71], v10, s[12:15], s28 offen
    s_add_u32 s28, s42, 16384
    buffer_load_dwordx4 v[72:75], v10, s[12:15], s28 offen
    s_add_u32 s28, s43, 16384
    buffer_load_dwordx4 v[76:79], v10, s[12:15], s28 offen
    s_add_u32 s28, s44, 16384
    buffer_load_dwordx4 v[80:83], v10, s[12:15], s28 offen
    s_add_u32 s29, s37, 40960
    buffer_load_dwordx4 v[120:123], v10, s[16:19], s29 offen offset:0
    buffer_load_dwordx4 v[124:127], v10, s[16:19], s29 offen offset:1024
    buffer_load_dwordx4 v[128:131], v10, s[16:19], s29 offen offset:2048
    buffer_load_dwordx4 v[132:135], v10, s[16:19], s29 offen offset:3072
    buffer_load_dwordx4 v[136:139], v11, s[16:19], s29 offen
    s_add_u32 s28, s41, 32768
    buffer_load_dwordx4 v[104:107], v10, s[12:15], s28 offen
    s_add_u32 s28, s42, 32768
    buffer_load_dwordx4 v[108:111], v10, s[12:15], s28 offen
    s_add_u32 s28, s43, 32768
    buffer_load_dwordx4 v[112:115], v10, s[12:15], s28 offen
    s_add_u32 s28, s44, 32768
    buffer_load_dwordx4 v[116:119], v10, s[12:15], s28 offen
    s_add_u32 s29, s37, 61440
    buffer_load_dwordx4 v[156:159], v10, s[16:19], s29 offen offset:0
    buffer_load_dwordx4 v[160:163], v10, s[16:19], s29 offen offset:1024
    buffer_load_dwordx4 v[164:167], v10, s[16:19], s29 offen offset:2048
    buffer_load_dwordx4 v[168:171], v10, s[16:19], s29 offen offset:3072
    buffer_load_dwordx4 v[172:175], v11, s[16:19], s29 offen
    s_add_u32 s28, s41, 49152
    buffer_load_dwordx4 v[140:143], v10, s[12:15], s28 offen
    s_add_u32 s28, s42, 49152
    buffer_load_dwordx4 v[144:147], v10, s[12:15], s28 offen
    s_add_u32 s28, s43, 49152
    buffer_load_dwordx4 v[148:151], v10, s[12:15], s28 offen
    s_add_u32 s28, s44, 49152
    buffer_load_dwordx4 v[152:155], v10, s[12:15], s28 offen
    s_add_u32 s29, s37, 81920
    buffer_load_dwordx4 v[192:195], v10, s[16:19], s29 offen offset:0
    buffer_load_dwordx4 v[196:199], v10, s[16:19], s29 offen offset:1024
    buffer_load_dwordx4 v[200:203], v10, s[16:19], s29 offen offset:2048
    buffer_load_dwordx4 v[204:207], v10, s[16:19], s29 offen offset:3072
    buffer_load_dwordx4 v[208:211], v11, s[16:19], s29 offen
    s_add_u32 s28, s41, 65536
    buffer_load_dwordx4 v[176:179], v10, s[12:15], s28 offen
    s_add_u32 s28, s42, 65536
    buffer_load_dwordx4 v[180:183], v10, s[12:15], s28 offen
    s_add_u32 s28, s43, 65536
    buffer_load_dwordx4 v[184:187], v10, s[12:15], s28 offen
    s_add_u32 s28, s44, 65536
    buffer_load_dwordx4 v[188:191], v10, s[12:15], s28 offen
    s_mov_b32 s20, s6
    s_and_b32 s21, s7, 0xffff
    s_mov_b32 s22, 2621440
    s_mov_b32 s23, 0x20000
    v_lshrrev_b32 v2, 4, v1
    v_and_b32 v3, 15, v1
    v_mul_u32_u24 v4, 336, v3
    v_lshlrev_b32 v5, 4, v2
    v_add_u32 v4, v4, v5
    s_mul_i32 s39, s24, 16128
    v_add_u32 v17, s39, v4
    s_add_u32 s39, s24, 1
    s_and_b32 s39, s39, 3
    s_mul_i32 s39, s39, 16128
    s_add_u32 s39, s39, 10752
    v_add_u32 v21, s39, v4
    s_add_u32 s39, s24, 2
    s_and_b32 s39, s39, 3
    s_mul_i32 s39, s39, 16128
    s_add_u32 s39, s39, 5376
    v_add_u32 v22, s39, v4
    s_add_u32 s39, s24, 3
    s_and_b32 s39, s39, 3
    s_mul_i32 s39, s39, 16128
    s_add_u32 s39, s39, 0
    v_add_u32 v23, s39, v4
    s_lshl_b32 s39, s24, 4
    s_add_u32 s39, s39, s25
    v_add_u32 v3, s39, v3
    v_mul_u32_u24 v3, 1280, v3
    v_lshlrev_b32 v5, 3, v2
    v_add_u32 v3, v3, v5
    s_lshl_b32 s39, s26, 1
    v_add_u32 v19, s39, v3
    s_waitcnt vmcnt(36)
    v_mfma_f32_16x16x32_bf16 a[0:3], v[48:51], v[32:35], 0
    v_mfma_f32_16x16x32_bf16 a[4:7], v[48:51], v[36:39], 0
    s_add_u32 s29, s37, 102400
    buffer_load_dwordx4 v[228:231], v10, s[16:19], s29 offen offset:0
    v_mfma_f32_16x16x32_bf16 a[8:11], v[48:51], v[40:43], 0
    v_mfma_f32_16x16x32_bf16 a[12:15], v[48:51], v[44:47], 0
    buffer_load_dwordx4 v[232:235], v10, s[16:19], s29 offen offset:1024
    v_mfma_f32_16x16x32_bf16 a[16:19], v[52:55], v[32:35], 0
    v_mfma_f32_16x16x32_bf16 a[20:23], v[52:55], v[36:39], 0
    buffer_load_dwordx4 v[236:239], v10, s[16:19], s29 offen offset:2048
    v_mfma_f32_16x16x32_bf16 a[24:27], v[52:55], v[40:43], 0
    v_mfma_f32_16x16x32_bf16 a[28:31], v[52:55], v[44:47], 0
    buffer_load_dwordx4 v[240:243], v10, s[16:19], s29 offen offset:3072
    v_mfma_f32_16x16x32_bf16 a[32:35], v[56:59], v[32:35], 0
    v_mfma_f32_16x16x32_bf16 a[36:39], v[56:59], v[36:39], 0
    buffer_load_dwordx4 v[244:247], v11, s[16:19], s29 offen
    v_mfma_f32_16x16x32_bf16 a[40:43], v[56:59], v[40:43], 0
    v_mfma_f32_16x16x32_bf16 a[44:47], v[56:59], v[44:47], 0
    s_add_u32 s28, s41, 81920
    buffer_load_dwordx4 v[212:215], v10, s[12:15], s28 offen
    v_mfma_f32_16x16x32_bf16 a[48:51], v[60:63], v[32:35], 0
    v_mfma_f32_16x16x32_bf16 a[52:55], v[60:63], v[36:39], 0
    s_add_u32 s28, s42, 81920
    buffer_load_dwordx4 v[216:219], v10, s[12:15], s28 offen
    v_mfma_f32_16x16x32_bf16 a[56:59], v[60:63], v[40:43], 0
    v_mfma_f32_16x16x32_bf16 a[60:63], v[60:63], v[44:47], 0
    s_add_u32 s28, s43, 81920
    buffer_load_dwordx4 v[220:223], v10, s[12:15], s28 offen
    v_mfma_f32_16x16x32_bf16 a[64:67], v[64:67], v[32:35], 0
    v_mfma_f32_16x16x32_bf16 a[68:71], v[64:67], v[36:39], 0
    s_add_u32 s28, s44, 81920
    buffer_load_dwordx4 v[224:227], v10, s[12:15], s28 offen
    v_mfma_f32_16x16x32_bf16 a[72:75], v[64:67], v[40:43], 0
    v_mfma_f32_16x16x32_bf16 a[76:79], v[64:67], v[44:47], 0
    s_waitcnt vmcnt(36)
    v_mfma_f32_16x16x32_bf16 a[0:3], v[84:87], v[68:71], a[0:3]
    v_mfma_f32_16x16x32_bf16 a[4:7], v[84:87], v[72:75], a[4:7]
    s_add_u32 s29, s37, 122880
    buffer_load_dwordx4 v[48:51], v10, s[16:19], s29 offen offset:0
    v_mfma_f32_16x16x32_bf16 a[8:11], v[84:87], v[76:79], a[8:11]
    v_mfma_f32_16x16x32_bf16 a[12:15], v[84:87], v[80:83], a[12:15]
    buffer_load_dwordx4 v[52:55], v10, s[16:19], s29 offen offset:1024
    v_mfma_f32_16x16x32_bf16 a[16:19], v[88:91], v[68:71], a[16:19]
    v_mfma_f32_16x16x32_bf16 a[20:23], v[88:91], v[72:75], a[20:23]
    buffer_load_dwordx4 v[56:59], v10, s[16:19], s29 offen offset:2048
    v_mfma_f32_16x16x32_bf16 a[24:27], v[88:91], v[76:79], a[24:27]
    v_mfma_f32_16x16x32_bf16 a[28:31], v[88:91], v[80:83], a[28:31]
    buffer_load_dwordx4 v[60:63], v10, s[16:19], s29 offen offset:3072
    v_mfma_f32_16x16x32_bf16 a[32:35], v[92:95], v[68:71], a[32:35]
    v_mfma_f32_16x16x32_bf16 a[36:39], v[92:95], v[72:75], a[36:39]
    buffer_load_dwordx4 v[64:67], v11, s[16:19], s29 offen
    v_mfma_f32_16x16x32_bf16 a[40:43], v[92:95], v[76:79], a[40:43]
    v_mfma_f32_16x16x32_bf16 a[44:47], v[92:95], v[80:83], a[44:47]
    s_add_u32 s28, s41, 98304
    buffer_load_dwordx4 v[32:35], v10, s[12:15], s28 offen
    v_mfma_f32_16x16x32_bf16 a[48:51], v[96:99], v[68:71], a[48:51]
    v_mfma_f32_16x16x32_bf16 a[52:55], v[96:99], v[72:75], a[52:55]
    s_add_u32 s28, s42, 98304
    buffer_load_dwordx4 v[36:39], v10, s[12:15], s28 offen
    v_mfma_f32_16x16x32_bf16 a[56:59], v[96:99], v[76:79], a[56:59]
    v_mfma_f32_16x16x32_bf16 a[60:63], v[96:99], v[80:83], a[60:63]
    s_add_u32 s28, s43, 98304
    buffer_load_dwordx4 v[40:43], v10, s[12:15], s28 offen
    v_mfma_f32_16x16x32_bf16 a[64:67], v[100:103], v[68:71], a[64:67]
    v_mfma_f32_16x16x32_bf16 a[68:71], v[100:103], v[72:75], a[68:71]
    s_add_u32 s28, s44, 98304
    buffer_load_dwordx4 v[44:47], v10, s[12:15], s28 offen
    v_mfma_f32_16x16x32_bf16 a[72:75], v[100:103], v[76:79], a[72:75]
    v_mfma_f32_16x16x32_bf16 a[76:79], v[100:103], v[80:83], a[76:79]
    s_waitcnt vmcnt(36)
    v_mfma_f32_16x16x32_bf16 a[0:3], v[120:123], v[104:107], a[0:3]
    v_mfma_f32_16x16x32_bf16 a[4:7], v[120:123], v[108:111], a[4:7]
    s_add_u32 s29, s37, 143360
    buffer_load_dwordx4 v[84:87], v10, s[16:19], s29 offen offset:0
    v_mfma_f32_16x16x32_bf16 a[8:11], v[120:123], v[112:115], a[8:11]
    v_mfma_f32_16x16x32_bf16 a[12:15], v[120:123], v[116:119], a[12:15]
    buffer_load_dwordx4 v[88:91], v10, s[16:19], s29 offen offset:1024
    v_mfma_f32_16x16x32_bf16 a[16:19], v[124:127], v[104:107], a[16:19]
    v_mfma_f32_16x16x32_bf16 a[20:23], v[124:127], v[108:111], a[20:23]
    buffer_load_dwordx4 v[92:95], v10, s[16:19], s29 offen offset:2048
    v_mfma_f32_16x16x32_bf16 a[24:27], v[124:127], v[112:115], a[24:27]
    v_mfma_f32_16x16x32_bf16 a[28:31], v[124:127], v[116:119], a[28:31]
    buffer_load_dwordx4 v[96:99], v10, s[16:19], s29 offen offset:3072
    v_mfma_f32_16x16x32_bf16 a[32:35], v[128:131], v[104:107], a[32:35]
    v_mfma_f32_16x16x32_bf16 a[36:39], v[128:131], v[108:111], a[36:39]
    buffer_load_dwordx4 v[100:103], v11, s[16:19], s29 offen
    v_mfma_f32_16x16x32_bf16 a[40:43], v[128:131], v[112:115], a[40:43]
    v_mfma_f32_16x16x32_bf16 a[44:47], v[128:131], v[116:119], a[44:47]
    s_add_u32 s28, s41, 114688
    buffer_load_dwordx4 v[68:71], v10, s[12:15], s28 offen
    v_mfma_f32_16x16x32_bf16 a[48:51], v[132:135], v[104:107], a[48:51]
    v_mfma_f32_16x16x32_bf16 a[52:55], v[132:135], v[108:111], a[52:55]
    s_add_u32 s28, s42, 114688
    buffer_load_dwordx4 v[72:75], v10, s[12:15], s28 offen
    v_mfma_f32_16x16x32_bf16 a[56:59], v[132:135], v[112:115], a[56:59]
    v_mfma_f32_16x16x32_bf16 a[60:63], v[132:135], v[116:119], a[60:63]
    s_add_u32 s28, s43, 114688
    buffer_load_dwordx4 v[76:79], v10, s[12:15], s28 offen
    v_mfma_f32_16x16x32_bf16 a[64:67], v[136:139], v[104:107], a[64:67]
    v_mfma_f32_16x16x32_bf16 a[68:71], v[136:139], v[108:111], a[68:71]
    s_add_u32 s28, s44, 114688
    buffer_load_dwordx4 v[80:83], v10, s[12:15], s28 offen
    v_mfma_f32_16x16x32_bf16 a[72:75], v[136:139], v[112:115], a[72:75]
    v_mfma_f32_16x16x32_bf16 a[76:79], v[136:139], v[116:119], a[76:79]
    s_waitcnt vmcnt(36)
    v_mfma_f32_16x16x32_bf16 a[0:3], v[156:159], v[140:143], a[0:3]
    v_mfma_f32_16x16x32_bf16 a[4:7], v[156:159], v[144:147], a[4:7]
    s_add_u32 s29, s37, 163840
    buffer_load_dwordx4 v[120:123], v10, s[16:19], s29 offen offset:0
    v_mfma_f32_16x16x32_bf16 a[8:11], v[156:159], v[148:151], a[8:11]
    v_mfma_f32_16x16x32_bf16 a[12:15], v[156:159], v[152:155], a[12:15]
    buffer_load_dwordx4 v[124:127], v10, s[16:19], s29 offen offset:1024
    v_mfma_f32_16x16x32_bf16 a[16:19], v[160:163], v[140:143], a[16:19]
    v_mfma_f32_16x16x32_bf16 a[20:23], v[160:163], v[144:147], a[20:23]
    buffer_load_dwordx4 v[128:131], v10, s[16:19], s29 offen offset:2048
    v_mfma_f32_16x16x32_bf16 a[24:27], v[160:163], v[148:151], a[24:27]
    v_mfma_f32_16x16x32_bf16 a[28:31], v[160:163], v[152:155], a[28:31]
    buffer_load_dwordx4 v[132:135], v10, s[16:19], s29 offen offset:3072
    v_mfma_f32_16x16x32_bf16 a[32:35], v[164:167], v[140:143], a[32:35]
    v_mfma_f32_16x16x32_bf16 a[36:39], v[164:167], v[144:147], a[36:39]
    buffer_load_dwordx4 v[136:139], v11, s[16:19], s29 offen
    v_mfma_f32_16x16x32_bf16 a[40:43], v[164:167], v[148:151], a[40:43]
    v_mfma_f32_16x16x32_bf16 a[44:47], v[164:167], v[152:155], a[44:47]
    s_add_u32 s28, s41, 131072
    buffer_load_dwordx4 v[104:107], v10, s[12:15], s28 offen
    v_mfma_f32_16x16x32_bf16 a[48:51], v[168:171], v[140:143], a[48:51]
    v_mfma_f32_16x16x32_bf16 a[52:55], v[168:171], v[144:147], a[52:55]
    s_add_u32 s28, s42, 131072
    buffer_load_dwordx4 v[108:111], v10, s[12:15], s28 offen
    v_mfma_f32_16x16x32_bf16 a[56:59], v[168:171], v[148:151], a[56:59]
    v_mfma_f32_16x16x32_bf16 a[60:63], v[168:171], v[152:155], a[60:63]
    s_add_u32 s28, s43, 131072
    buffer_load_dwordx4 v[112:115], v10, s[12:15], s28 offen
    v_mfma_f32_16x16x32_bf16 a[64:67], v[172:175], v[140:143], a[64:67]
    v_mfma_f32_16x16x32_bf16 a[68:71], v[172:175], v[144:147], a[68:71]
    s_add_u32 s28, s44, 131072
    buffer_load_dwordx4 v[116:119], v10, s[12:15], s28 offen
    v_mfma_f32_16x16x32_bf16 a[72:75], v[172:175], v[148:151], a[72:75]
    v_mfma_f32_16x16x32_bf16 a[76:79], v[172:175], v[152:155], a[76:79]
    s_waitcnt vmcnt(36)
    v_mfma_f32_16x16x32_bf16 a[0:3], v[192:195], v[176:179], a[0:3]
    v_mfma_f32_16x16x32_bf16 a[4:7], v[192:195], v[180:183], a[4:7]
    s_add_u32 s29, s37, 184320
    buffer_load_dwordx4 v[156:159], v10, s[16:19], s29 offen offset:0
    v_mfma_f32_16x16x32_bf16 a[8:11], v[192:195], v[184:187], a[8:11]
    v_mfma_f32_16x16x32_bf16 a[12:15], v[192:195], v[188:191], a[12:15]
    buffer_load_dwordx4 v[160:163], v10, s[16:19], s29 offen offset:1024
    v_mfma_f32_16x16x32_bf16 a[16:19], v[196:199], v[176:179], a[16:19]
    v_mfma_f32_16x16x32_bf16 a[20:23], v[196:199], v[180:183], a[20:23]
    buffer_load_dwordx4 v[164:167], v10, s[16:19], s29 offen offset:2048
    v_mfma_f32_16x16x32_bf16 a[24:27], v[196:199], v[184:187], a[24:27]
    v_mfma_f32_16x16x32_bf16 a[28:31], v[196:199], v[188:191], a[28:31]
    buffer_load_dwordx4 v[168:171], v10, s[16:19], s29 offen offset:3072
    v_mfma_f32_16x16x32_bf16 a[32:35], v[200:203], v[176:179], a[32:35]
    v_mfma_f32_16x16x32_bf16 a[36:39], v[200:203], v[180:183], a[36:39]
    buffer_load_dwordx4 v[172:175], v11, s[16:19], s29 offen
    v_mfma_f32_16x16x32_bf16 a[40:43], v[200:203], v[184:187], a[40:43]
    v_mfma_f32_16x16x32_bf16 a[44:47], v[200:203], v[188:191], a[44:47]
    s_add_u32 s28, s41, 147456
    buffer_load_dwordx4 v[140:143], v10, s[12:15], s28 offen
    v_mfma_f32_16x16x32_bf16 a[48:51], v[204:207], v[176:179], a[48:51]
    v_mfma_f32_16x16x32_bf16 a[52:55], v[204:207], v[180:183], a[52:55]
    s_add_u32 s28, s42, 147456
    buffer_load_dwordx4 v[144:147], v10, s[12:15], s28 offen
    v_mfma_f32_16x16x32_bf16 a[56:59], v[204:207], v[184:187], a[56:59]
    v_mfma_f32_16x16x32_bf16 a[60:63], v[204:207], v[188:191], a[60:63]
    s_add_u32 s28, s43, 147456
    buffer_load_dwordx4 v[148:151], v10, s[12:15], s28 offen
    v_mfma_f32_16x16x32_bf16 a[64:67], v[208:211], v[176:179], a[64:67]
    v_mfma_f32_16x16x32_bf16 a[68:71], v[208:211], v[180:183], a[68:71]
    s_add_u32 s28, s44, 147456
    buffer_load_dwordx4 v[152:155], v10, s[12:15], s28 offen
    v_mfma_f32_16x16x32_bf16 a[72:75], v[208:211], v[184:187], a[72:75]
    v_mfma_f32_16x16x32_bf16 a[76:79], v[208:211], v[188:191], a[76:79]
    s_waitcnt vmcnt(36)
    v_mfma_f32_16x16x32_bf16 a[0:3], v[228:231], v[212:215], a[0:3]
    v_mfma_f32_16x16x32_bf16 a[4:7], v[228:231], v[216:219], a[4:7]
    s_add_u32 s29, s37, 204800
    buffer_load_dwordx4 v[192:195], v10, s[16:19], s29 offen offset:0
    v_mfma_f32_16x16x32_bf16 a[8:11], v[228:231], v[220:223], a[8:11]
    v_mfma_f32_16x16x32_bf16 a[12:15], v[228:231], v[224:227], a[12:15]
    buffer_load_dwordx4 v[196:199], v10, s[16:19], s29 offen offset:1024
    v_mfma_f32_16x16x32_bf16 a[16:19], v[232:235], v[212:215], a[16:19]
    v_mfma_f32_16x16x32_bf16 a[20:23], v[232:235], v[216:219], a[20:23]
    buffer_load_dwordx4 v[200:203], v10, s[16:19], s29 offen offset:2048
    v_mfma_f32_16x16x32_bf16 a[24:27], v[232:235], v[220:223], a[24:27]
    v_mfma_f32_16x16x32_bf16 a[28:31], v[232:235], v[224:227], a[28:31]
    buffer_load_dwordx4 v[204:207], v10, s[16:19], s29 offen offset:3072
    v_mfma_f32_16x16x32_bf16 a[32:35], v[236:239], v[212:215], a[32:35]
    v_mfma_f32_16x16x32_bf16 a[36:39], v[236:239], v[216:219], a[36:39]
    buffer_load_dwordx4 v[208:211], v11, s[16:19], s29 offen
    v_mfma_f32_16x16x32_bf16 a[40:43], v[236:239], v[220:223], a[40:43]
    v_mfma_f32_16x16x32_bf16 a[44:47], v[236:239], v[224:227], a[44:47]
    s_add_u32 s28, s41, 163840
    buffer_load_dwordx4 v[176:179], v10, s[12:15], s28 offen
    v_mfma_f32_16x16x32_bf16 a[48:51], v[240:243], v[212:215], a[48:51]
    v_mfma_f32_16x16x32_bf16 a[52:55], v[240:243], v[216:219], a[52:55]
    s_add_u32 s28, s42, 163840
    buffer_load_dwordx4 v[180:183], v10, s[12:15], s28 offen
    v_mfma_f32_16x16x32_bf16 a[56:59], v[240:243], v[220:223], a[56:59]
    v_mfma_f32_16x16x32_bf16 a[60:63], v[240:243], v[224:227], a[60:63]
    s_add_u32 s28, s43, 163840
    buffer_load_dwordx4 v[184:187], v10, s[12:15], s28 offen
    v_mfma_f32_16x16x32_bf16 a[64:67], v[244:247], v[212:215], a[64:67]
    v_mfma_f32_16x16x32_bf16 a[68:71], v[244:247], v[216:219], a[68:71]
    s_add_u32 s28, s44, 163840
    buffer_load_dwordx4 v[188:191], v10, s[12:15], s28 offen
    v_mfma_f32_16x16x32_bf16 a[72:75], v[244:247], v[220:223], a[72:75]
    v_mfma_f32_16x16x32_bf16 a[76:79], v[244:247], v[224:227], a[76:79]
    s_waitcnt vmcnt(36)
    v_mfma_f32_16x16x32_bf16 a[0:3], v[48:51], v[32:35], a[0:3]
    v_mfma_f32_16x16x32_bf16 a[4:7], v[48:51], v[36:39], a[4:7]
    s_add_u32 s29, s37, 225280
    buffer_load_dwordx4 v[228:231], v10, s[16:19], s29 offen offset:0
    v_mfma_f32_16x16x32_bf16 a[8:11], v[48:51], v[40:43], a[8:11]
    v_mfma_f32_16x16x32_bf16 a[12:15], v[48:51], v[44:47], a[12:15]
    buffer_load_dwordx4 v[232:235], v10, s[16:19], s29 offen offset:1024
    v_mfma_f32_16x16x32_bf16 a[16:19], v[52:55], v[32:35], a[16:19]
    v_mfma_f32_16x16x32_bf16 a[20:23], v[52:55], v[36:39], a[20:23]
    buffer_load_dwordx4 v[236:239], v10, s[16:19], s29 offen offset:2048
    v_mfma_f32_16x16x32_bf16 a[24:27], v[52:55], v[40:43], a[24:27]
    v_mfma_f32_16x16x32_bf16 a[28:31], v[52:55], v[44:47], a[28:31]
    buffer_load_dwordx4 v[240:243], v10, s[16:19], s29 offen offset:3072
    v_mfma_f32_16x16x32_bf16 a[32:35], v[56:59], v[32:35], a[32:35]
    v_mfma_f32_16x16x32_bf16 a[36:39], v[56:59], v[36:39], a[36:39]
    buffer_load_dwordx4 v[244:247], v11, s[16:19], s29 offen
    v_mfma_f32_16x16x32_bf16 a[40:43], v[56:59], v[40:43], a[40:43]
    v_mfma_f32_16x16x32_bf16 a[44:47], v[56:59], v[44:47], a[44:47]
    s_add_u32 s28, s41, 180224
    buffer_load_dwordx4 v[212:215], v10, s[12:15], s28 offen
    v_mfma_f32_16x16x32_bf16 a[48:51], v[60:63], v[32:35], a[48:51]
    v_mfma_f32_16x16x32_bf16 a[52:55], v[60:63], v[36:39], a[52:55]
    s_add_u32 s28, s42, 180224
    buffer_load_dwordx4 v[216:219], v10, s[12:15], s28 offen
    v_mfma_f32_16x16x32_bf16 a[56:59], v[60:63], v[40:43], a[56:59]
    v_mfma_f32_16x16x32_bf16 a[60:63], v[60:63], v[44:47], a[60:63]
    s_add_u32 s28, s43, 180224
    buffer_load_dwordx4 v[220:223], v10, s[12:15], s28 offen
    v_mfma_f32_16x16x32_bf16 a[64:67], v[64:67], v[32:35], a[64:67]
    v_mfma_f32_16x16x32_bf16 a[68:71], v[64:67], v[36:39], a[68:71]
    s_add_u32 s28, s44, 180224
    buffer_load_dwordx4 v[224:227], v10, s[12:15], s28 offen
    v_mfma_f32_16x16x32_bf16 a[72:75], v[64:67], v[40:43], a[72:75]
    v_mfma_f32_16x16x32_bf16 a[76:79], v[64:67], v[44:47], a[76:79]
    s_waitcnt vmcnt(36)
    v_mfma_f32_16x16x32_bf16 a[0:3], v[84:87], v[68:71], a[0:3]
    v_mfma_f32_16x16x32_bf16 a[4:7], v[84:87], v[72:75], a[4:7]
    s_add_u32 s29, s37, 245760
    buffer_load_dwordx4 v[48:51], v10, s[16:19], s29 offen offset:0
    v_mfma_f32_16x16x32_bf16 a[8:11], v[84:87], v[76:79], a[8:11]
    v_mfma_f32_16x16x32_bf16 a[12:15], v[84:87], v[80:83], a[12:15]
    buffer_load_dwordx4 v[52:55], v10, s[16:19], s29 offen offset:1024
    v_mfma_f32_16x16x32_bf16 a[16:19], v[88:91], v[68:71], a[16:19]
    v_mfma_f32_16x16x32_bf16 a[20:23], v[88:91], v[72:75], a[20:23]
    buffer_load_dwordx4 v[56:59], v10, s[16:19], s29 offen offset:2048
    v_mfma_f32_16x16x32_bf16 a[24:27], v[88:91], v[76:79], a[24:27]
    v_mfma_f32_16x16x32_bf16 a[28:31], v[88:91], v[80:83], a[28:31]
    buffer_load_dwordx4 v[60:63], v10, s[16:19], s29 offen offset:3072
    v_mfma_f32_16x16x32_bf16 a[32:35], v[92:95], v[68:71], a[32:35]
    v_mfma_f32_16x16x32_bf16 a[36:39], v[92:95], v[72:75], a[36:39]
    buffer_load_dwordx4 v[64:67], v11, s[16:19], s29 offen
    v_mfma_f32_16x16x32_bf16 a[40:43], v[92:95], v[76:79], a[40:43]
    v_mfma_f32_16x16x32_bf16 a[44:47], v[92:95], v[80:83], a[44:47]
    s_add_u32 s28, s41, 196608
    buffer_load_dwordx4 v[32:35], v10, s[12:15], s28 offen
    v_mfma_f32_16x16x32_bf16 a[48:51], v[96:99], v[68:71], a[48:51]
    v_mfma_f32_16x16x32_bf16 a[52:55], v[96:99], v[72:75], a[52:55]
    s_add_u32 s28, s42, 196608
    buffer_load_dwordx4 v[36:39], v10, s[12:15], s28 offen
    v_mfma_f32_16x16x32_bf16 a[56:59], v[96:99], v[76:79], a[56:59]
    v_mfma_f32_16x16x32_bf16 a[60:63], v[96:99], v[80:83], a[60:63]
    s_add_u32 s28, s43, 196608
    buffer_load_dwordx4 v[40:43], v10, s[12:15], s28 offen
    v_mfma_f32_16x16x32_bf16 a[64:67], v[100:103], v[68:71], a[64:67]
    v_mfma_f32_16x16x32_bf16 a[68:71], v[100:103], v[72:75], a[68:71]
    s_add_u32 s28, s44, 196608
    buffer_load_dwordx4 v[44:47], v10, s[12:15], s28 offen
    v_mfma_f32_16x16x32_bf16 a[72:75], v[100:103], v[76:79], a[72:75]
    v_mfma_f32_16x16x32_bf16 a[76:79], v[100:103], v[80:83], a[76:79]
    s_waitcnt vmcnt(36)
    v_mfma_f32_16x16x32_bf16 a[0:3], v[120:123], v[104:107], a[0:3]
    v_mfma_f32_16x16x32_bf16 a[4:7], v[120:123], v[108:111], a[4:7]
    s_add_u32 s29, s37, 266240
    buffer_load_dwordx4 v[84:87], v10, s[16:19], s29 offen offset:0
    v_mfma_f32_16x16x32_bf16 a[8:11], v[120:123], v[112:115], a[8:11]
    v_mfma_f32_16x16x32_bf16 a[12:15], v[120:123], v[116:119], a[12:15]
    buffer_load_dwordx4 v[88:91], v10, s[16:19], s29 offen offset:1024
    v_mfma_f32_16x16x32_bf16 a[16:19], v[124:127], v[104:107], a[16:19]
    v_mfma_f32_16x16x32_bf16 a[20:23], v[124:127], v[108:111], a[20:23]
    buffer_load_dwordx4 v[92:95], v10, s[16:19], s29 offen offset:2048
    v_mfma_f32_16x16x32_bf16 a[24:27], v[124:127], v[112:115], a[24:27]
    v_mfma_f32_16x16x32_bf16 a[28:31], v[124:127], v[116:119], a[28:31]
    buffer_load_dwordx4 v[96:99], v10, s[16:19], s29 offen offset:3072
    v_mfma_f32_16x16x32_bf16 a[32:35], v[128:131], v[104:107], a[32:35]
    v_mfma_f32_16x16x32_bf16 a[36:39], v[128:131], v[108:111], a[36:39]
    buffer_load_dwordx4 v[100:103], v11, s[16:19], s29 offen
    v_mfma_f32_16x16x32_bf16 a[40:43], v[128:131], v[112:115], a[40:43]
    v_mfma_f32_16x16x32_bf16 a[44:47], v[128:131], v[116:119], a[44:47]
    s_add_u32 s28, s41, 212992
    buffer_load_dwordx4 v[68:71], v10, s[12:15], s28 offen
    v_mfma_f32_16x16x32_bf16 a[48:51], v[132:135], v[104:107], a[48:51]
    v_mfma_f32_16x16x32_bf16 a[52:55], v[132:135], v[108:111], a[52:55]
    s_add_u32 s28, s42, 212992
    buffer_load_dwordx4 v[72:75], v10, s[12:15], s28 offen
    v_mfma_f32_16x16x32_bf16 a[56:59], v[132:135], v[112:115], a[56:59]
    v_mfma_f32_16x16x32_bf16 a[60:63], v[132:135], v[116:119], a[60:63]
    s_add_u32 s28, s43, 212992
    buffer_load_dwordx4 v[76:79], v10, s[12:15], s28 offen
    v_mfma_f32_16x16x32_bf16 a[64:67], v[136:139], v[104:107], a[64:67]
    v_mfma_f32_16x16x32_bf16 a[68:71], v[136:139], v[108:111], a[68:71]
    s_add_u32 s28, s44, 212992
    buffer_load_dwordx4 v[80:83], v10, s[12:15], s28 offen
    v_mfma_f32_16x16x32_bf16 a[72:75], v[136:139], v[112:115], a[72:75]
    v_mfma_f32_16x16x32_bf16 a[76:79], v[136:139], v[116:119], a[76:79]
    s_waitcnt vmcnt(36)
    v_mfma_f32_16x16x32_bf16 a[0:3], v[156:159], v[140:143], a[0:3]
    v_mfma_f32_16x16x32_bf16 a[4:7], v[156:159], v[144:147], a[4:7]
    v_mfma_f32_16x16x32_bf16 a[8:11], v[156:159], v[148:151], a[8:11]
    v_mfma_f32_16x16x32_bf16 a[12:15], v[156:159], v[152:155], a[12:15]
    v_mfma_f32_16x16x32_bf16 a[16:19], v[160:163], v[140:143], a[16:19]
    v_mfma_f32_16x16x32_bf16 a[20:23], v[160:163], v[144:147], a[20:23]
    v_mfma_f32_16x16x32_bf16 a[24:27], v[160:163], v[148:151], a[24:27]
    v_mfma_f32_16x16x32_bf16 a[28:31], v[160:163], v[152:155], a[28:31]
    v_mfma_f32_16x16x32_bf16 a[32:35], v[164:167], v[140:143], a[32:35]
    v_mfma_f32_16x16x32_bf16 a[36:39], v[164:167], v[144:147], a[36:39]
    v_mfma_f32_16x16x32_bf16 a[40:43], v[164:167], v[148:151], a[40:43]
    v_mfma_f32_16x16x32_bf16 a[44:47], v[164:167], v[152:155], a[44:47]
    v_mfma_f32_16x16x32_bf16 a[48:51], v[168:171], v[140:143], a[48:51]
    v_mfma_f32_16x16x32_bf16 a[52:55], v[168:171], v[144:147], a[52:55]
    v_mfma_f32_16x16x32_bf16 a[56:59], v[168:171], v[148:151], a[56:59]
    v_mfma_f32_16x16x32_bf16 a[60:63], v[168:171], v[152:155], a[60:63]
    v_mfma_f32_16x16x32_bf16 a[64:67], v[172:175], v[140:143], a[64:67]
    v_mfma_f32_16x16x32_bf16 a[68:71], v[172:175], v[144:147], a[68:71]
    v_mfma_f32_16x16x32_bf16 a[72:75], v[172:175], v[148:151], a[72:75]
    v_mfma_f32_16x16x32_bf16 a[76:79], v[172:175], v[152:155], a[76:79]
    s_waitcnt vmcnt(27)
    v_mfma_f32_16x16x32_bf16 a[0:3], v[192:195], v[176:179], a[0:3]
    v_mfma_f32_16x16x32_bf16 a[4:7], v[192:195], v[180:183], a[4:7]
    v_mfma_f32_16x16x32_bf16 a[8:11], v[192:195], v[184:187], a[8:11]
    v_mfma_f32_16x16x32_bf16 a[12:15], v[192:195], v[188:191], a[12:15]
    v_mfma_f32_16x16x32_bf16 a[16:19], v[196:199], v[176:179], a[16:19]
    v_mfma_f32_16x16x32_bf16 a[20:23], v[196:199], v[180:183], a[20:23]
    v_mfma_f32_16x16x32_bf16 a[24:27], v[196:199], v[184:187], a[24:27]
    v_mfma_f32_16x16x32_bf16 a[28:31], v[196:199], v[188:191], a[28:31]
    v_mfma_f32_16x16x32_bf16 a[32:35], v[200:203], v[176:179], a[32:35]
    v_mfma_f32_16x16x32_bf16 a[36:39], v[200:203], v[180:183], a[36:39]
    v_mfma_f32_16x16x32_bf16 a[40:43], v[200:203], v[184:187], a[40:43]
    v_mfma_f32_16x16x32_bf16 a[44:47], v[200:203], v[188:191], a[44:47]
    v_mfma_f32_16x16x32_bf16 a[48:51], v[204:207], v[176:179], a[48:51]
    v_mfma_f32_16x16x32_bf16 a[52:55], v[204:207], v[180:183], a[52:55]
    v_mfma_f32_16x16x32_bf16 a[56:59], v[204:207], v[184:187], a[56:59]
    v_mfma_f32_16x16x32_bf16 a[60:63], v[204:207], v[188:191], a[60:63]
    v_mfma_f32_16x16x32_bf16 a[64:67], v[208:211], v[176:179], a[64:67]
    v_mfma_f32_16x16x32_bf16 a[68:71], v[208:211], v[180:183], a[68:71]
    v_mfma_f32_16x16x32_bf16 a[72:75], v[208:211], v[184:187], a[72:75]
    v_mfma_f32_16x16x32_bf16 a[76:79], v[208:211], v[188:191], a[76:79]
    s_waitcnt vmcnt(18)
    v_mfma_f32_16x16x32_bf16 a[0:3], v[228:231], v[212:215], a[0:3]
    v_mfma_f32_16x16x32_bf16 a[4:7], v[228:231], v[216:219], a[4:7]
    v_mfma_f32_16x16x32_bf16 a[8:11], v[228:231], v[220:223], a[8:11]
    v_mfma_f32_16x16x32_bf16 a[12:15], v[228:231], v[224:227], a[12:15]
    v_mfma_f32_16x16x32_bf16 a[16:19], v[232:235], v[212:215], a[16:19]
    v_mfma_f32_16x16x32_bf16 a[20:23], v[232:235], v[216:219], a[20:23]
    v_mfma_f32_16x16x32_bf16 a[24:27], v[232:235], v[220:223], a[24:27]
    v_mfma_f32_16x16x32_bf16 a[28:31], v[232:235], v[224:227], a[28:31]
    v_mfma_f32_16x16x32_bf16 a[32:35], v[236:239], v[212:215], a[32:35]
    v_mfma_f32_16x16x32_bf16 a[36:39], v[236:239], v[216:219], a[36:39]
    v_mfma_f32_16x16x32_bf16 a[40:43], v[236:239], v[220:223], a[40:43]
    v_mfma_f32_16x16x32_bf16 a[44:47], v[236:239], v[224:227], a[44:47]
    v_mfma_f32_16x16x32_bf16 a[48:51], v[240:243], v[212:215], a[48:51]
    v_mfma_f32_16x16x32_bf16 a[52:55], v[240:243], v[216:219], a[52:55]
    v_mfma_f32_16x16x32_bf16 a[56:59], v[240:243], v[220:223], a[56:59]
    v_mfma_f32_16x16x32_bf16 a[60:63], v[240:243], v[224:227], a[60:63]
    v_mfma_f32_16x16x32_bf16 a[64:67], v[244:247], v[212:215], a[64:67]
    v_mfma_f32_16x16x32_bf16 a[68:71], v[244:247], v[216:219], a[68:71]
    v_mfma_f32_16x16x32_bf16 a[72:75], v[244:247], v[220:223], a[72:75]
    v_mfma_f32_16x16x32_bf16 a[76:79], v[244:247], v[224:227], a[76:79]
    s_waitcnt vmcnt(9)
    v_mfma_f32_16x16x32_bf16 a[0:3], v[48:51], v[32:35], a[0:3]
    v_mfma_f32_16x16x32_bf16 a[4:7], v[48:51], v[36:39], a[4:7]
    v_mfma_f32_16x16x32_bf16 a[8:11], v[48:51], v[40:43], a[8:11]
    v_mfma_f32_16x16x32_bf16 a[12:15], v[48:51], v[44:47], a[12:15]
    v_mfma_f32_16x16x32_bf16 a[16:19], v[52:55], v[32:35], a[16:19]
    v_mfma_f32_16x16x32_bf16 a[20:23], v[52:55], v[36:39], a[20:23]
    v_mfma_f32_16x16x32_bf16 a[24:27], v[52:55], v[40:43], a[24:27]
    v_mfma_f32_16x16x32_bf16 a[28:31], v[52:55], v[44:47], a[28:31]
    v_mfma_f32_16x16x32_bf16 a[32:35], v[56:59], v[32:35], a[32:35]
    v_mfma_f32_16x16x32_bf16 a[36:39], v[56:59], v[36:39], a[36:39]
    v_mfma_f32_16x16x32_bf16 a[40:43], v[56:59], v[40:43], a[40:43]
    v_mfma_f32_16x16x32_bf16 a[44:47], v[56:59], v[44:47], a[44:47]
    v_mfma_f32_16x16x32_bf16 a[48:51], v[60:63], v[32:35], a[48:51]
    v_mfma_f32_16x16x32_bf16 a[52:55], v[60:63], v[36:39], a[52:55]
    v_mfma_f32_16x16x32_bf16 a[56:59], v[60:63], v[40:43], a[56:59]
    v_mfma_f32_16x16x32_bf16 a[60:63], v[60:63], v[44:47], a[60:63]
    v_mfma_f32_16x16x32_bf16 a[64:67], v[64:67], v[32:35], a[64:67]
    v_mfma_f32_16x16x32_bf16 a[68:71], v[64:67], v[36:39], a[68:71]
    v_mfma_f32_16x16x32_bf16 a[72:75], v[64:67], v[40:43], a[72:75]
    v_mfma_f32_16x16x32_bf16 a[76:79], v[64:67], v[44:47], a[76:79]
    s_waitcnt vmcnt(0)
    v_mfma_f32_16x16x32_bf16 a[4:7], v[84:87], v[72:75], a[4:7]
    v_mfma_f32_16x16x32_bf16 a[8:11], v[84:87], v[76:79], a[8:11]
    v_mfma_f32_16x16x32_bf16 a[12:15], v[84:87], v[80:83], a[12:15]
    v_mfma_f32_16x16x32_bf16 a[20:23], v[88:91], v[72:75], a[20:23]
    v_mfma_f32_16x16x32_bf16 a[24:27], v[88:91], v[76:79], a[24:27]
    v_mfma_f32_16x16x32_bf16 a[28:31], v[88:91], v[80:83], a[28:31]
    v_mfma_f32_16x16x32_bf16 a[36:39], v[92:95], v[72:75], a[36:39]
    v_mfma_f32_16x16x32_bf16 a[40:43], v[92:95], v[76:79], a[40:43]
    v_mfma_f32_16x16x32_bf16 a[44:47], v[92:95], v[80:83], a[44:47]
    v_mfma_f32_16x16x32_bf16 a[52:55], v[96:99], v[72:75], a[52:55]
    v_mfma_f32_16x16x32_bf16 a[56:59], v[96:99], v[76:79], a[56:59]
    v_mfma_f32_16x16x32_bf16 a[60:63], v[96:99], v[80:83], a[60:63]
    v_mfma_f32_16x16x32_bf16 a[68:71], v[100:103], v[72:75], a[68:71]
    v_mfma_f32_16x16x32_bf16 a[72:75], v[100:103], v[76:79], a[72:75]
    v_mfma_f32_16x16x32_bf16 a[76:79], v[100:103], v[80:83], a[76:79]
    v_mfma_f32_16x16x32_bf16 a[0:3], v[84:87], v[68:71], a[0:3]
    ds_write_b128 v21, a[4:7] offset:0
    ds_write_b128 v22, a[8:11] offset:0
    v_mfma_f32_16x16x32_bf16 a[16:19], v[88:91], v[68:71], a[16:19]
    ds_write_b128 v23, a[12:15] offset:0
    ds_write_b128 v21, a[20:23] offset:64
    v_mfma_f32_16x16x32_bf16 a[32:35], v[92:95], v[68:71], a[32:35]
    ds_write_b128 v22, a[24:27] offset:64
    ds_write_b128 v23, a[28:31] offset:64
    v_mfma_f32_16x16x32_bf16 a[48:51], v[96:99], v[68:71], a[48:51]
    ds_write_b128 v21, a[36:39] offset:128
    ds_write_b128 v22, a[40:43] offset:128
    v_mfma_f32_16x16x32_bf16 a[64:67], v[100:103], v[68:71], a[64:67]
    ds_write_b128 v23, a[44:47] offset:128
    ds_write_b128 v21, a[52:55] offset:192
    ds_write_b128 v22, a[56:59] offset:192
    ds_write_b128 v23, a[60:63] offset:192
    ds_write_b128 v21, a[68:71] offset:256
    ds_write_b128 v22, a[72:75] offset:256
    ds_write_b128 v23, a[76:79] offset:256
    s_waitcnt lgkmcnt(0)
    s_barrier
    ds_read_b128 v[32:35], v17 offset:0
    ds_read_b128 v[36:39], v17 offset:64
    ds_read_b128 v[40:43], v17 offset:128
    ds_read_b128 v[44:47], v17 offset:192
    ds_read_b128 v[48:51], v17 offset:256
    ds_read_b128 v[52:55], v17 offset:5376
    ds_read_b128 v[56:59], v17 offset:5440
    ds_read_b128 v[60:63], v17 offset:5504
    ds_read_b128 v[64:67], v17 offset:5568
    ds_read_b128 v[68:71], v17 offset:5632
    ds_read_b128 v[72:75], v17 offset:10752
    ds_read_b128 v[76:79], v17 offset:10816
    ds_read_b128 v[80:83], v17 offset:10880
    ds_read_b128 v[84:87], v17 offset:10944
    ds_read_b128 v[88:91], v17 offset:11008
    v_accvgpr_read_b32 v92, a0
    v_accvgpr_read_b32 v93, a1
    v_accvgpr_read_b32 v94, a2
    v_accvgpr_read_b32 v95, a3
    v_accvgpr_read_b32 v96, a16
    v_accvgpr_read_b32 v97, a17
    v_accvgpr_read_b32 v98, a18
    v_accvgpr_read_b32 v99, a19
    v_accvgpr_read_b32 v100, a32
    v_accvgpr_read_b32 v101, a33
    v_accvgpr_read_b32 v102, a34
    v_accvgpr_read_b32 v103, a35
    v_accvgpr_read_b32 v104, a48
    v_accvgpr_read_b32 v105, a49
    v_accvgpr_read_b32 v106, a50
    v_accvgpr_read_b32 v107, a51
    v_accvgpr_read_b32 v108, a64
    v_accvgpr_read_b32 v109, a65
    v_accvgpr_read_b32 v110, a66
    v_accvgpr_read_b32 v111, a67
    s_waitcnt lgkmcnt(0)
    v_add_f32 v32, v32, v52
    v_add_f32 v72, v72, v92
    v_add_f32 v33, v33, v53
    v_add_f32 v73, v73, v93
    v_add_f32 v34, v34, v54
    v_add_f32 v74, v74, v94
    v_add_f32 v35, v35, v55
    v_add_f32 v75, v75, v95
    v_add_f32 v36, v36, v56
    v_add_f32 v76, v76, v96
    v_add_f32 v37, v37, v57
    v_add_f32 v77, v77, v97
    v_add_f32 v38, v38, v58
    v_add_f32 v78, v78, v98
    v_add_f32 v39, v39, v59
    v_add_f32 v79, v79, v99
    v_add_f32 v40, v40, v60
    v_add_f32 v80, v80, v100
    v_add_f32 v41, v41, v61
    v_add_f32 v81, v81, v101
    v_add_f32 v42, v42, v62
    v_add_f32 v82, v82, v102
    v_add_f32 v43, v43, v63
    v_add_f32 v83, v83, v103
    v_add_f32 v44, v44, v64
    v_add_f32 v84, v84, v104
    v_add_f32 v45, v45, v65
    v_add_f32 v85, v85, v105
    v_add_f32 v46, v46, v66
    v_add_f32 v86, v86, v106
    v_add_f32 v47, v47, v67
    v_add_f32 v87, v87, v107
    v_add_f32 v48, v48, v68
    v_add_f32 v88, v88, v108
    v_add_f32 v49, v49, v69
    v_add_f32 v89, v89, v109
    v_add_f32 v50, v50, v70
    v_add_f32 v90, v90, v110
    v_add_f32 v51, v51, v71
    v_add_f32 v91, v91, v111
    v_add_f32 v32, v32, v72
    v_add_f32 v33, v33, v73
    v_add_f32 v34, v34, v74
    v_add_f32 v35, v35, v75
    v_add_f32 v36, v36, v76
    v_add_f32 v37, v37, v77
    v_add_f32 v38, v38, v78
    v_add_f32 v39, v39, v79
    v_add_f32 v40, v40, v80
    v_add_f32 v41, v41, v81
    v_add_f32 v42, v42, v82
    v_add_f32 v43, v43, v83
    v_add_f32 v44, v44, v84
    v_add_f32 v45, v45, v85
    v_add_f32 v46, v46, v86
    v_add_f32 v47, v47, v87
    v_add_f32 v48, v48, v88
    v_add_f32 v49, v49, v89
    v_add_f32 v50, v50, v90
    v_add_f32 v51, v51, v91
    v_cvt_pk_bf16_f32 v112, v32, v33
    v_cvt_pk_bf16_f32 v113, v34, v35
    v_cvt_pk_bf16_f32 v114, v36, v37
    v_cvt_pk_bf16_f32 v115, v38, v39
    v_cvt_pk_bf16_f32 v116, v40, v41
    v_cvt_pk_bf16_f32 v117, v42, v43
    v_cvt_pk_bf16_f32 v118, v44, v45
    v_cvt_pk_bf16_f32 v119, v46, v47
    v_cvt_pk_bf16_f32 v120, v48, v49
    v_cvt_pk_bf16_f32 v121, v50, v51
    buffer_store_dwordx2 v[112:113], v19, s[20:23], 0 offen offset:0
    buffer_store_dwordx2 v[114:115], v19, s[20:23], 0 offen offset:32
    buffer_store_dwordx2 v[116:117], v19, s[20:23], 0 offen offset:64
    buffer_store_dwordx2 v[118:119], v19, s[20:23], 0 offen offset:96
    buffer_store_dwordx2 v[120:121], v19, s[20:23], 0 offen offset:128
    s_waitcnt vmcnt(0)
L2_end:
    s_endpgm
.section .rodata,"a"
.p2align 6
.amdhsa_kernel ffn1_kernel
  .amdhsa_next_free_vgpr 128
  .amdhsa_next_free_sgpr 102
  .amdhsa_accum_offset 128
  .amdhsa_group_segment_fixed_size 0
  .amdhsa_kernarg_size 48
  .amdhsa_user_sgpr_count 2
  .amdhsa_user_sgpr_kernarg_segment_ptr 1
  .amdhsa_system_sgpr_workgroup_id_x 1
.end_amdhsa_kernel
.p2align 6
.amdhsa_kernel ffn2_kernel
  .amdhsa_next_free_vgpr 336
  .amdhsa_next_free_sgpr 102
  .amdhsa_accum_offset 256
  .amdhsa_group_segment_fixed_size 0
  .amdhsa_kernarg_size 48
  .amdhsa_user_sgpr_count 2
  .amdhsa_user_sgpr_kernarg_segment_ptr 1
  .amdhsa_system_sgpr_workgroup_id_x 1
.end_amdhsa_kernel
```
